```python
import torch

def _softmax(x, axis=-1):
    return torch.softmax(x, dim=axis)
def _gelu(x):
    return torch.nn.functional.gelu(x, approximate="tanh")
def _silu(x):
    return torch.nn.functional.silu(x)
def _sigmoid(x):
    return torch.sigmoid(x)
def _layernorm(x, axis=-1, eps=1e-5):
    m = x.mean(dim=axis, keepdim=True)
    v = x.var(dim=axis, keepdim=True, unbiased=False)
    return (x - m) / torch.sqrt(v + eps)
def _scatter_add(tgt, idx, src, axis=0):
    return tgt.clone().index_add_(axis, idx, src)
def _segment_sum(src, seg, n):
    out = torch.zeros((n,) + src.shape[1:], dtype=src.dtype)
    return out.index_add_(0, seg, src)
def _pad(x, pw):
    flat = tuple(v for pair in reversed(pw) for v in pair)
    return torch.nn.functional.pad(x, flat)

kernel_name = 'standalone__softmax_full_bidir__sampling'

def setup_inputs():

    _w = (lambda a: (lambda t: t.to(torch.bfloat16) if t.is_floating_point() else t)(torch.as_tensor(a)))
    B, H, Sq, Skv, Dh = 16, 32, 4, 4096, 128
    return {
        "q": _w((lambda *s: torch.randn(*s, dtype=torch.bfloat16) * 0.8)(B, H, Sq, Dh)),
        "k": _w((lambda *s: torch.randn(*s, dtype=torch.bfloat16) * 0.8)(B, H, Skv, Dh)),
        "v": _w((lambda *s: torch.randn(*s, dtype=torch.bfloat16) * 0.05)(B, H, Skv, Dh)),
    }

def reference(q, k, v):
    scale = q.shape[-1] ** -0.5
    scores = torch.einsum('bhqd,bhkd->bhqk', q, k) * scale
    attn = _softmax(scores, axis=-1)
    return torch.einsum('bhqk,bhkd->bhqd', attn, v)
```

```asm
; @launch grid=(256,1,1) block=(128,1,1) lds=132096
.amdgcn_target "amdgcn-amd-amdhsa--gfx950"
.text
.globl standalone__softmax_full_bidir__sampling_kernel
.p2align 8
.type standalone__softmax_full_bidir__sampling_kernel,@function
standalone__softmax_full_bidir__sampling_kernel:
    s_cmp_ge_u32 s2, 256
    s_cbranch_scc1 L_end
    s_load_dwordx4 s[24:27], s[0:1], 0
    s_load_dwordx4 s[28:31], s[0:1], 16
    s_load_dwordx2 s[68:69], s[0:1], 40
    s_cmp_ge_u32 s2, 16
    s_cbranch_scc1 L_nopf
    s_getpc_b64 s[10:11]
L_pc:
    v_lshlrev_b32 v58, 7, v0
    v_min_u32 v58, L_end-L_pc, v58
    v_mov_b32 v59, s11
    v_add_co_u32 v58, vcc, s10, v58
    s_nop 1
    v_addc_co_u32 v59, vcc, 0, v59, vcc
    global_load_dword v17, v[58:59], off
L_nopf:
    v_lshrrev_b32 v21, 6, v0
    v_and_b32 v0, 63, v0
    v_readfirstlane_b32 s23, v21
    v_lshrrev_b32 v21, 4, v0
    v_lshlrev_b32 v1, 6, v21
    v_and_b32 v21, 3, v0
    v_lshl_add_u32 v1, v21, 4, v1
    v_bfe_u32 v21, v0, 2, 2
    v_lshl_add_u32 v57, v21, 8, v1
    v_lshl_add_u32 v1, v21, 15, v1
    s_lshl_b32 s36, s2, 1
    s_add_u32 s36, s36, s23
    s_lshl_b32 s32, s36, 20
    s_lshl_b32 s34, s36, 10
    s_mul_i32 s20, s23, 0x80000
    s_mov_b32 s6, 0x100000
    s_mov_b32 s7, 0x20000
    s_mov_b32 s14, 1024
    s_mov_b32 s15, 0x20000
    s_waitcnt lgkmcnt(0)
    s_add_u32 s4, s26, s32
    s_addc_u32 s5, s27, 0
    s_add_u32 s12, s24, s34
    s_addc_u32 s13, s25, 0
    buffer_load_dwordx4 v[4:7], v57, s[12:15], 0 offen
    buffer_load_dwordx4 v[60:63], v1, s[4:7], s20 offen offset:0 nt
    buffer_load_dwordx4 v[64:67], v1, s[4:7], s20 offen offset:2048 nt
    buffer_load_dwordx4 v[68:71], v1, s[4:7], s20 offen offset:256 nt
    buffer_load_dwordx4 v[72:75], v1, s[4:7], s20 offen offset:2304 nt
    s_xor_b32 s67, s20, 0x4000
    buffer_load_dwordx4 v[76:79], v1, s[4:7], s67 offen offset:0 nt
    buffer_load_dwordx4 v[80:83], v1, s[4:7], s67 offen offset:2048 nt
    buffer_load_dwordx4 v[84:87], v1, s[4:7], s67 offen offset:256 nt
    buffer_load_dwordx4 v[88:91], v1, s[4:7], s67 offen offset:2304 nt
    s_xor_b32 s67, s20, 0x2000
    buffer_load_dwordx4 v[92:95], v1, s[4:7], s67 offen offset:0 nt
    buffer_load_dwordx4 v[96:99], v1, s[4:7], s67 offen offset:2048 nt
    buffer_load_dwordx4 v[100:103], v1, s[4:7], s67 offen offset:256 nt
    buffer_load_dwordx4 v[104:107], v1, s[4:7], s67 offen offset:2304 nt
    s_xor_b32 s67, s20, 0x6000
    buffer_load_dwordx4 v[108:111], v1, s[4:7], s67 offen offset:0 nt
    buffer_load_dwordx4 v[112:115], v1, s[4:7], s67 offen offset:2048 nt
    buffer_load_dwordx4 v[116:119], v1, s[4:7], s67 offen offset:256 nt
    buffer_load_dwordx4 v[120:123], v1, s[4:7], s67 offen offset:2304 nt
    s_add_u32 s8, s28, s32
    s_addc_u32 s9, s29, 0
    s_add_u32 s16, s30, s34
    s_addc_u32 s17, s31, 0
    s_mov_b32 s18, 1024
    s_mov_b32 s19, 0x20000
    s_load_dword s70, s[8:9], 0
    s_lshl_b32 s57, s36, 8
    s_mov_b32 s65, 0
    s_cmp_ge_u32 s36, 176
    s_cbranch_scc1 L_noclr
    s_atomic_and s65, s[68:69], s57
L_noclr:
    s_mov_b32 s72, 0x80000
    s_mov_b32 s73, 0xc0000
    s_mov_b32 s74, 0xc0200
    s_mov_b32 s75, 0xe0200
    s_mov_b32 s76, 0xe0600
    s_mov_b32 s77, 0xe1600
    s_mov_b32 s78, 0xe1600
    s_mov_b32 s79, 0xe1600
    s_mov_b32 s22, 0x3e0293ee
    s_mov_b32 s21, 0
    s_mov_b32 s61, 0
    s_mov_b32 s62, 0
    s_mov_b32 s66, 1
    s_mov_b32 s33, 0
    s_mov_b32 s59, 0
    s_mov_b32 s39, 1
    s_lshr_b32 s64, s2, 3
    s_and_b32 s63, s2, 7
    s_lshl_b32 s38, s23, 16
    v_lshlrev_b32 v56, 4, v0
    v_and_b32 v2, 0xf0, v56
    v_bfe_u32 v21, v0, 4, 1
    v_lshl_add_u32 v2, v21, 15, v2
    v_bfe_u32 v21, v0, 5, 1
    v_lshl_add_u32 v2, v21, 16, v2
    v_mov_b32 v8, 0
    v_mov_b32 v9, 0
    v_mov_b32 v10, 0
    v_mov_b32 v11, 0
    v_mov_b32 v12, 0
    v_mov_b32 v13, 0
    v_mov_b32 v14, 0
    v_mov_b32 v15, 0
    v_mov_b32 v16, 0xff800000
    v_mov_b32 v18, 0
    v_and_b32 v21, 1, v0
    v_lshlrev_b32 v21, 4, v21
    v_mov_b32 v38, 0xffff
    v_lshlrev_b32 v38, v21, v38
    v_and_b32 v21, 2, v0
    v_cmp_eq_u32 vcc, 0, v21
    v_lshrrev_b32 v21, 2, v0
    v_lshl_add_u32 v3, v21, 4, s38
    v_cndmask_b32 v19, 0, v38, vcc
    v_xor_b32 v20, v38, v19
    v_lshl_add_u32 v22, v0, 2, s38
    s_waitcnt vmcnt(14)
    v_mfma_f32_16x16x32_bf16 v[24:27], v[60:63], v[4:7], 0
    s_add_u32 s21, s21, 1
    s_ff1_i32_b32 m0, s21
    s_nop 0
    s_movrels_b32 s67, s72
    s_xor_b32 s20, s20, s67
    s_mov_b32 s80, 0x300300
    s_mov_b32 s81, 0xc3003003
    s_mov_b32 s82, 0x100100
    s_mov_b32 s83, 0x1001001
L_plan1:
    s_sub_u32 s57, s21, 1
    s_lshr_b64 s[10:11], s[80:81], s57
    s_ff1_i32_b64 s57, s[10:11]
    s_add_u32 s60, s21, s57
    s_add_u32 s60, s60, 1
    s_mov_b32 s58, s66
    s_cmp_lg_u32 s61, 0
    s_cbranch_scc1 L_boost1
L_pick1:
    s_cmp_lg_u32 s58, 1
    s_cbranch_scc1 L_other1
L_loop1_1:
    v_mfma_f32_16x16x32_bf16 v[28:31], v[64:67], v[4:7], 0
    v_mov_b32_dpp v32, v24 quad_perm:[0,0,0,0] row_mask:0xf bank_mask:0xf
    s_nop 1
    v_add_f32_dpp v32, v25, v32 quad_perm:[1,1,1,1] row_mask:0xf bank_mask:0xf
    s_nop 1
    v_add_f32_dpp v32, v26, v32 quad_perm:[2,2,2,2] row_mask:0xf bank_mask:0xf
    s_nop 1
    v_add_f32_dpp v32, v27, v32 quad_perm:[3,3,3,3] row_mask:0xf bank_mask:0xf
    s_waitcnt vmcnt(9)
    buffer_load_dwordx4 v[60:63], v1, s[4:7], s20 offen offset:0 nt
    v_mfma_f32_16x16x32_bf16 v[24:27], v[68:71], v[4:7], 0
    v_mov_b32_dpp v33, v28 quad_perm:[0,0,0,0] row_mask:0xf bank_mask:0xf
    s_nop 1
    v_add_f32_dpp v33, v29, v33 quad_perm:[1,1,1,1] row_mask:0xf bank_mask:0xf
    s_nop 1
    v_add_f32_dpp v33, v30, v33 quad_perm:[2,2,2,2] row_mask:0xf bank_mask:0xf
    s_nop 1
    v_add_f32_dpp v33, v31, v33 quad_perm:[3,3,3,3] row_mask:0xf bank_mask:0xf
    s_waitcnt vmcnt(9)
    buffer_load_dwordx4 v[64:67], v1, s[4:7], s20 offen offset:2048 nt
    v_mfma_f32_16x16x32_bf16 v[28:31], v[72:75], v[4:7], 0
    v_mov_b32_dpp v34, v24 quad_perm:[0,0,0,0] row_mask:0xf bank_mask:0xf
    s_nop 1
    v_add_f32_dpp v34, v25, v34 quad_perm:[1,1,1,1] row_mask:0xf bank_mask:0xf
    s_nop 1
    v_add_f32_dpp v34, v26, v34 quad_perm:[2,2,2,2] row_mask:0xf bank_mask:0xf
    s_nop 1
    v_add_f32_dpp v34, v27, v34 quad_perm:[3,3,3,3] row_mask:0xf bank_mask:0xf
    s_waitcnt vmcnt(9)
    buffer_load_dwordx4 v[68:71], v1, s[4:7], s20 offen offset:256 nt
    v_mfma_f32_16x16x32_bf16 v[24:27], v[76:79], v[4:7], 0
    v_mov_b32_dpp v35, v28 quad_perm:[0,0,0,0] row_mask:0xf bank_mask:0xf
    s_nop 1
    v_add_f32_dpp v35, v29, v35 quad_perm:[1,1,1,1] row_mask:0xf bank_mask:0xf
    s_nop 1
    v_add_f32_dpp v35, v30, v35 quad_perm:[2,2,2,2] row_mask:0xf bank_mask:0xf
    s_nop 1
    v_add_f32_dpp v35, v31, v35 quad_perm:[3,3,3,3] row_mask:0xf bank_mask:0xf
    ds_write_b128 v3, v[32:35] offset:0
    v_max3_f32 v16, v16, v32, v33
    v_max3_f32 v16, v16, v34, v35
    s_waitcnt vmcnt(9)
    buffer_load_dwordx4 v[72:75], v1, s[4:7], s20 offen offset:2304 nt
    v_mfma_f32_16x16x32_bf16 v[28:31], v[80:83], v[4:7], 0
    v_mov_b32_dpp v32, v24 quad_perm:[0,0,0,0] row_mask:0xf bank_mask:0xf
    s_nop 1
    v_add_f32_dpp v32, v25, v32 quad_perm:[1,1,1,1] row_mask:0xf bank_mask:0xf
    s_nop 1
    v_add_f32_dpp v32, v26, v32 quad_perm:[2,2,2,2] row_mask:0xf bank_mask:0xf
    s_nop 1
    v_add_f32_dpp v32, v27, v32 quad_perm:[3,3,3,3] row_mask:0xf bank_mask:0xf
    s_xor_b32 s67, s20, 0x4000
    s_waitcnt vmcnt(9)
    buffer_load_dwordx4 v[76:79], v1, s[4:7], s67 offen offset:0 nt
    v_mfma_f32_16x16x32_bf16 v[24:27], v[84:87], v[4:7], 0
    v_mov_b32_dpp v33, v28 quad_perm:[0,0,0,0] row_mask:0xf bank_mask:0xf
    s_nop 1
    v_add_f32_dpp v33, v29, v33 quad_perm:[1,1,1,1] row_mask:0xf bank_mask:0xf
    s_nop 1
    v_add_f32_dpp v33, v30, v33 quad_perm:[2,2,2,2] row_mask:0xf bank_mask:0xf
    s_nop 1
    v_add_f32_dpp v33, v31, v33 quad_perm:[3,3,3,3] row_mask:0xf bank_mask:0xf
    s_waitcnt vmcnt(9)
    buffer_load_dwordx4 v[80:83], v1, s[4:7], s67 offen offset:2048 nt
    v_mfma_f32_16x16x32_bf16 v[28:31], v[88:91], v[4:7], 0
    v_mov_b32_dpp v34, v24 quad_perm:[0,0,0,0] row_mask:0xf bank_mask:0xf
    s_nop 1
    v_add_f32_dpp v34, v25, v34 quad_perm:[1,1,1,1] row_mask:0xf bank_mask:0xf
    s_nop 1
    v_add_f32_dpp v34, v26, v34 quad_perm:[2,2,2,2] row_mask:0xf bank_mask:0xf
    s_nop 1
    v_add_f32_dpp v34, v27, v34 quad_perm:[3,3,3,3] row_mask:0xf bank_mask:0xf
    s_waitcnt vmcnt(9)
    buffer_load_dwordx4 v[84:87], v1, s[4:7], s67 offen offset:256 nt
    v_mfma_f32_16x16x32_bf16 v[24:27], v[92:95], v[4:7], 0
    v_mov_b32_dpp v35, v28 quad_perm:[0,0,0,0] row_mask:0xf bank_mask:0xf
    s_nop 1
    v_add_f32_dpp v35, v29, v35 quad_perm:[1,1,1,1] row_mask:0xf bank_mask:0xf
    s_nop 1
    v_add_f32_dpp v35, v30, v35 quad_perm:[2,2,2,2] row_mask:0xf bank_mask:0xf
    s_nop 1
    v_add_f32_dpp v35, v31, v35 quad_perm:[3,3,3,3] row_mask:0xf bank_mask:0xf
    ds_write_b128 v3, v[32:35] offset:256
    v_max3_f32 v16, v16, v32, v33
    v_max3_f32 v16, v16, v34, v35
    s_waitcnt vmcnt(9)
    buffer_load_dwordx4 v[88:91], v1, s[4:7], s67 offen offset:2304 nt
    v_mfma_f32_16x16x32_bf16 v[28:31], v[96:99], v[4:7], 0
    v_mov_b32_dpp v32, v24 quad_perm:[0,0,0,0] row_mask:0xf bank_mask:0xf
    s_nop 1
    v_add_f32_dpp v32, v25, v32 quad_perm:[1,1,1,1] row_mask:0xf bank_mask:0xf
    s_nop 1
    v_add_f32_dpp v32, v26, v32 quad_perm:[2,2,2,2] row_mask:0xf bank_mask:0xf
    s_nop 1
    v_add_f32_dpp v32, v27, v32 quad_perm:[3,3,3,3] row_mask:0xf bank_mask:0xf
    s_xor_b32 s67, s20, 0x2000
    s_waitcnt vmcnt(9)
    buffer_load_dwordx4 v[92:95], v1, s[4:7], s67 offen offset:0 nt
    v_mfma_f32_16x16x32_bf16 v[24:27], v[100:103], v[4:7], 0
    v_mov_b32_dpp v33, v28 quad_perm:[0,0,0,0] row_mask:0xf bank_mask:0xf
    s_nop 1
    v_add_f32_dpp v33, v29, v33 quad_perm:[1,1,1,1] row_mask:0xf bank_mask:0xf
    s_nop 1
    v_add_f32_dpp v33, v30, v33 quad_perm:[2,2,2,2] row_mask:0xf bank_mask:0xf
    s_nop 1
    v_add_f32_dpp v33, v31, v33 quad_perm:[3,3,3,3] row_mask:0xf bank_mask:0xf
    s_waitcnt vmcnt(9)
    buffer_load_dwordx4 v[96:99], v1, s[4:7], s67 offen offset:2048 nt
    v_mfma_f32_16x16x32_bf16 v[28:31], v[104:107], v[4:7], 0
    v_mov_b32_dpp v34, v24 quad_perm:[0,0,0,0] row_mask:0xf bank_mask:0xf
    s_nop 1
    v_add_f32_dpp v34, v25, v34 quad_perm:[1,1,1,1] row_mask:0xf bank_mask:0xf
    s_nop 1
    v_add_f32_dpp v34, v26, v34 quad_perm:[2,2,2,2] row_mask:0xf bank_mask:0xf
    s_nop 1
    v_add_f32_dpp v34, v27, v34 quad_perm:[3,3,3,3] row_mask:0xf bank_mask:0xf
    s_waitcnt vmcnt(9)
    buffer_load_dwordx4 v[100:103], v1, s[4:7], s67 offen offset:256 nt
    v_mfma_f32_16x16x32_bf16 v[24:27], v[108:111], v[4:7], 0
    v_mov_b32_dpp v35, v28 quad_perm:[0,0,0,0] row_mask:0xf bank_mask:0xf
    s_nop 1
    v_add_f32_dpp v35, v29, v35 quad_perm:[1,1,1,1] row_mask:0xf bank_mask:0xf
    s_nop 1
    v_add_f32_dpp v35, v30, v35 quad_perm:[2,2,2,2] row_mask:0xf bank_mask:0xf
    s_nop 1
    v_add_f32_dpp v35, v31, v35 quad_perm:[3,3,3,3] row_mask:0xf bank_mask:0xf
    ds_write_b128 v3, v[32:35] offset:512
    v_max3_f32 v16, v16, v32, v33
    v_max3_f32 v16, v16, v34, v35
    s_waitcnt vmcnt(9)
    buffer_load_dwordx4 v[104:107], v1, s[4:7], s67 offen offset:2304 nt
    v_mfma_f32_16x16x32_bf16 v[28:31], v[112:115], v[4:7], 0
    v_mov_b32_dpp v32, v24 quad_perm:[0,0,0,0] row_mask:0xf bank_mask:0xf
    s_nop 1
    v_add_f32_dpp v32, v25, v32 quad_perm:[1,1,1,1] row_mask:0xf bank_mask:0xf
    s_nop 1
    v_add_f32_dpp v32, v26, v32 quad_perm:[2,2,2,2] row_mask:0xf bank_mask:0xf
    s_nop 1
    v_add_f32_dpp v32, v27, v32 quad_perm:[3,3,3,3] row_mask:0xf bank_mask:0xf
    s_xor_b32 s67, s20, 0x6000
    s_waitcnt vmcnt(9)
    buffer_load_dwordx4 v[108:111], v1, s[4:7], s67 offen offset:0 nt
    v_mfma_f32_16x16x32_bf16 v[24:27], v[116:119], v[4:7], 0
    v_mov_b32_dpp v33, v28 quad_perm:[0,0,0,0] row_mask:0xf bank_mask:0xf
    s_nop 1
    v_add_f32_dpp v33, v29, v33 quad_perm:[1,1,1,1] row_mask:0xf bank_mask:0xf
    s_nop 1
    v_add_f32_dpp v33, v30, v33 quad_perm:[2,2,2,2] row_mask:0xf bank_mask:0xf
    s_nop 1
    v_add_f32_dpp v33, v31, v33 quad_perm:[3,3,3,3] row_mask:0xf bank_mask:0xf
    s_waitcnt vmcnt(9)
    buffer_load_dwordx4 v[112:115], v1, s[4:7], s67 offen offset:2048 nt
    v_mfma_f32_16x16x32_bf16 v[28:31], v[120:123], v[4:7], 0
    v_mov_b32_dpp v34, v24 quad_perm:[0,0,0,0] row_mask:0xf bank_mask:0xf
    s_nop 1
    v_add_f32_dpp v34, v25, v34 quad_perm:[1,1,1,1] row_mask:0xf bank_mask:0xf
    s_nop 1
    v_add_f32_dpp v34, v26, v34 quad_perm:[2,2,2,2] row_mask:0xf bank_mask:0xf
    s_nop 1
    v_add_f32_dpp v34, v27, v34 quad_perm:[3,3,3,3] row_mask:0xf bank_mask:0xf
    s_waitcnt vmcnt(9)
    buffer_load_dwordx4 v[116:119], v1, s[4:7], s67 offen offset:256 nt
    v_mfma_f32_16x16x32_bf16 v[24:27], v[60:63], v[4:7], 0
    v_mov_b32_dpp v35, v28 quad_perm:[0,0,0,0] row_mask:0xf bank_mask:0xf
    s_nop 1
    v_add_f32_dpp v35, v29, v35 quad_perm:[1,1,1,1] row_mask:0xf bank_mask:0xf
    s_nop 1
    v_add_f32_dpp v35, v30, v35 quad_perm:[2,2,2,2] row_mask:0xf bank_mask:0xf
    s_nop 1
    v_add_f32_dpp v35, v31, v35 quad_perm:[3,3,3,3] row_mask:0xf bank_mask:0xf
    ds_write_b128 v3, v[32:35] offset:768
    v_max3_f32 v16, v16, v32, v33
    v_max3_f32 v16, v16, v34, v35
    v_add_u32 v3, 1024, v3
    s_waitcnt vmcnt(9)
    buffer_load_dwordx4 v[120:123], v1, s[4:7], s67 offen offset:2304 nt
    s_add_u32 s21, s21, 1
    s_ff1_i32_b32 m0, s21
    s_nop 0
    s_movrels_b32 s67, s72
    s_xor_b32 s20, s20, s67
    s_cmp_lg_u32 s21, s60
    s_cbranch_scc1 L_loop1_1
    s_branch L_ctl1
L_loop1_3:
    v_mfma_f32_16x16x32_bf16 v[28:31], v[64:67], v[4:7], 0
    v_mov_b32_dpp v32, v24 quad_perm:[0,0,0,0] row_mask:0xf bank_mask:0xf
    s_nop 1
    v_add_f32_dpp v32, v25, v32 quad_perm:[1,1,1,1] row_mask:0xf bank_mask:0xf
    s_nop 1
    v_add_f32_dpp v32, v26, v32 quad_perm:[2,2,2,2] row_mask:0xf bank_mask:0xf
    s_nop 1
    v_add_f32_dpp v32, v27, v32 quad_perm:[3,3,3,3] row_mask:0xf bank_mask:0xf
    s_waitcnt vmcnt(11)
    buffer_load_dwordx4 v[60:63], v1, s[4:7], s20 offen offset:0 nt
    v_mfma_f32_16x16x32_bf16 v[24:27], v[68:71], v[4:7], 0
    v_mov_b32_dpp v33, v28 quad_perm:[0,0,0,0] row_mask:0xf bank_mask:0xf
    s_nop 1
    v_add_f32_dpp v33, v29, v33 quad_perm:[1,1,1,1] row_mask:0xf bank_mask:0xf
    s_nop 1
    v_add_f32_dpp v33, v30, v33 quad_perm:[2,2,2,2] row_mask:0xf bank_mask:0xf
    s_nop 1
    v_add_f32_dpp v33, v31, v33 quad_perm:[3,3,3,3] row_mask:0xf bank_mask:0xf
    s_waitcnt vmcnt(11)
    buffer_load_dwordx4 v[64:67], v1, s[4:7], s20 offen offset:2048 nt
    v_mfma_f32_16x16x32_bf16 v[28:31], v[72:75], v[4:7], 0
    v_mov_b32_dpp v34, v24 quad_perm:[0,0,0,0] row_mask:0xf bank_mask:0xf
    s_nop 1
    v_add_f32_dpp v34, v25, v34 quad_perm:[1,1,1,1] row_mask:0xf bank_mask:0xf
    s_nop 1
    v_add_f32_dpp v34, v26, v34 quad_perm:[2,2,2,2] row_mask:0xf bank_mask:0xf
    s_nop 1
    v_add_f32_dpp v34, v27, v34 quad_perm:[3,3,3,3] row_mask:0xf bank_mask:0xf
    s_waitcnt vmcnt(11)
    buffer_load_dwordx4 v[68:71], v1, s[4:7], s20 offen offset:256 nt
    v_mfma_f32_16x16x32_bf16 v[24:27], v[76:79], v[4:7], 0
    v_mov_b32_dpp v35, v28 quad_perm:[0,0,0,0] row_mask:0xf bank_mask:0xf
    s_nop 1
    v_add_f32_dpp v35, v29, v35 quad_perm:[1,1,1,1] row_mask:0xf bank_mask:0xf
    s_nop 1
    v_add_f32_dpp v35, v30, v35 quad_perm:[2,2,2,2] row_mask:0xf bank_mask:0xf
    s_nop 1
    v_add_f32_dpp v35, v31, v35 quad_perm:[3,3,3,3] row_mask:0xf bank_mask:0xf
    ds_write_b128 v3, v[32:35] offset:0
    v_max3_f32 v16, v16, v32, v33
    v_max3_f32 v16, v16, v34, v35
    s_waitcnt vmcnt(11)
    buffer_load_dwordx4 v[72:75], v1, s[4:7], s20 offen offset:2304 nt
    v_mfma_f32_16x16x32_bf16 v[28:31], v[80:83], v[4:7], 0
    v_mov_b32_dpp v32, v24 quad_perm:[0,0,0,0] row_mask:0xf bank_mask:0xf
    s_nop 1
    v_add_f32_dpp v32, v25, v32 quad_perm:[1,1,1,1] row_mask:0xf bank_mask:0xf
    s_nop 1
    v_add_f32_dpp v32, v26, v32 quad_perm:[2,2,2,2] row_mask:0xf bank_mask:0xf
    s_nop 1
    v_add_f32_dpp v32, v27, v32 quad_perm:[3,3,3,3] row_mask:0xf bank_mask:0xf
    s_xor_b32 s67, s20, 0x4000
    s_waitcnt vmcnt(11)
    buffer_load_dwordx4 v[76:79], v1, s[4:7], s67 offen offset:0 nt
    v_mfma_f32_16x16x32_bf16 v[24:27], v[84:87], v[4:7], 0
    v_mov_b32_dpp v33, v28 quad_perm:[0,0,0,0] row_mask:0xf bank_mask:0xf
    s_nop 1
    v_add_f32_dpp v33, v29, v33 quad_perm:[1,1,1,1] row_mask:0xf bank_mask:0xf
    s_nop 1
    v_add_f32_dpp v33, v30, v33 quad_perm:[2,2,2,2] row_mask:0xf bank_mask:0xf
    s_nop 1
    v_add_f32_dpp v33, v31, v33 quad_perm:[3,3,3,3] row_mask:0xf bank_mask:0xf
    s_waitcnt vmcnt(11)
    buffer_load_dwordx4 v[80:83], v1, s[4:7], s67 offen offset:2048 nt
    v_mfma_f32_16x16x32_bf16 v[28:31], v[88:91], v[4:7], 0
    v_mov_b32_dpp v34, v24 quad_perm:[0,0,0,0] row_mask:0xf bank_mask:0xf
    s_nop 1
    v_add_f32_dpp v34, v25, v34 quad_perm:[1,1,1,1] row_mask:0xf bank_mask:0xf
    s_nop 1
    v_add_f32_dpp v34, v26, v34 quad_perm:[2,2,2,2] row_mask:0xf bank_mask:0xf
    s_nop 1
    v_add_f32_dpp v34, v27, v34 quad_perm:[3,3,3,3] row_mask:0xf bank_mask:0xf
    s_waitcnt vmcnt(11)
    buffer_load_dwordx4 v[84:87], v1, s[4:7], s67 offen offset:256 nt
    v_mfma_f32_16x16x32_bf16 v[24:27], v[92:95], v[4:7], 0
    v_mov_b32_dpp v35, v28 quad_perm:[0,0,0,0] row_mask:0xf bank_mask:0xf
    s_nop 1
    v_add_f32_dpp v35, v29, v35 quad_perm:[1,1,1,1] row_mask:0xf bank_mask:0xf
    s_nop 1
    v_add_f32_dpp v35, v30, v35 quad_perm:[2,2,2,2] row_mask:0xf bank_mask:0xf
    s_nop 1
    v_add_f32_dpp v35, v31, v35 quad_perm:[3,3,3,3] row_mask:0xf bank_mask:0xf
    ds_write_b128 v3, v[32:35] offset:256
    v_max3_f32 v16, v16, v32, v33
    v_max3_f32 v16, v16, v34, v35
    s_waitcnt vmcnt(11)
    buffer_load_dwordx4 v[88:91], v1, s[4:7], s67 offen offset:2304 nt
    v_mfma_f32_16x16x32_bf16 v[28:31], v[96:99], v[4:7], 0
    v_mov_b32_dpp v32, v24 quad_perm:[0,0,0,0] row_mask:0xf bank_mask:0xf
    s_nop 1
    v_add_f32_dpp v32, v25, v32 quad_perm:[1,1,1,1] row_mask:0xf bank_mask:0xf
    s_nop 1
    v_add_f32_dpp v32, v26, v32 quad_perm:[2,2,2,2] row_mask:0xf bank_mask:0xf
    s_nop 1
    v_add_f32_dpp v32, v27, v32 quad_perm:[3,3,3,3] row_mask:0xf bank_mask:0xf
    s_xor_b32 s67, s20, 0x2000
    s_waitcnt vmcnt(11)
    buffer_load_dwordx4 v[92:95], v1, s[4:7], s67 offen offset:0 nt
    v_mfma_f32_16x16x32_bf16 v[24:27], v[100:103], v[4:7], 0
    v_mov_b32_dpp v33, v28 quad_perm:[0,0,0,0] row_mask:0xf bank_mask:0xf
    s_nop 1
    v_add_f32_dpp v33, v29, v33 quad_perm:[1,1,1,1] row_mask:0xf bank_mask:0xf
    s_nop 1
    v_add_f32_dpp v33, v30, v33 quad_perm:[2,2,2,2] row_mask:0xf bank_mask:0xf
    s_nop 1
    v_add_f32_dpp v33, v31, v33 quad_perm:[3,3,3,3] row_mask:0xf bank_mask:0xf
    s_waitcnt vmcnt(11)
    buffer_load_dwordx4 v[96:99], v1, s[4:7], s67 offen offset:2048 nt
    v_mfma_f32_16x16x32_bf16 v[28:31], v[104:107], v[4:7], 0
    v_mov_b32_dpp v34, v24 quad_perm:[0,0,0,0] row_mask:0xf bank_mask:0xf
    s_nop 1
    v_add_f32_dpp v34, v25, v34 quad_perm:[1,1,1,1] row_mask:0xf bank_mask:0xf
    s_nop 1
    v_add_f32_dpp v34, v26, v34 quad_perm:[2,2,2,2] row_mask:0xf bank_mask:0xf
    s_nop 1
    v_add_f32_dpp v34, v27, v34 quad_perm:[3,3,3,3] row_mask:0xf bank_mask:0xf
    s_waitcnt vmcnt(11)
    buffer_load_dwordx4 v[100:103], v1, s[4:7], s67 offen offset:256 nt
    v_mfma_f32_16x16x32_bf16 v[24:27], v[108:111], v[4:7], 0
    v_mov_b32_dpp v35, v28 quad_perm:[0,0,0,0] row_mask:0xf bank_mask:0xf
    s_nop 1
    v_add_f32_dpp v35, v29, v35 quad_perm:[1,1,1,1] row_mask:0xf bank_mask:0xf
    s_nop 1
    v_add_f32_dpp v35, v30, v35 quad_perm:[2,2,2,2] row_mask:0xf bank_mask:0xf
    s_nop 1
    v_add_f32_dpp v35, v31, v35 quad_perm:[3,3,3,3] row_mask:0xf bank_mask:0xf
    ds_write_b128 v3, v[32:35] offset:512
    v_max3_f32 v16, v16, v32, v33
    v_max3_f32 v16, v16, v34, v35
    s_waitcnt vmcnt(11)
    buffer_load_dwordx4 v[104:107], v1, s[4:7], s67 offen offset:2304 nt
    v_mfma_f32_16x16x32_bf16 v[28:31], v[112:115], v[4:7], 0
    v_mov_b32_dpp v32, v24 quad_perm:[0,0,0,0] row_mask:0xf bank_mask:0xf
    s_nop 1
    v_add_f32_dpp v32, v25, v32 quad_perm:[1,1,1,1] row_mask:0xf bank_mask:0xf
    s_nop 1
    v_add_f32_dpp v32, v26, v32 quad_perm:[2,2,2,2] row_mask:0xf bank_mask:0xf
    s_nop 1
    v_add_f32_dpp v32, v27, v32 quad_perm:[3,3,3,3] row_mask:0xf bank_mask:0xf
    s_xor_b32 s67, s20, 0x6000
    s_waitcnt vmcnt(11)
    buffer_load_dwordx4 v[108:111], v1, s[4:7], s67 offen offset:0 nt
    v_mfma_f32_16x16x32_bf16 v[24:27], v[116:119], v[4:7], 0
    v_mov_b32_dpp v33, v28 quad_perm:[0,0,0,0] row_mask:0xf bank_mask:0xf
    s_nop 1
    v_add_f32_dpp v33, v29, v33 quad_perm:[1,1,1,1] row_mask:0xf bank_mask:0xf
    s_nop 1
    v_add_f32_dpp v33, v30, v33 quad_perm:[2,2,2,2] row_mask:0xf bank_mask:0xf
    s_nop 1
    v_add_f32_dpp v33, v31, v33 quad_perm:[3,3,3,3] row_mask:0xf bank_mask:0xf
    s_waitcnt vmcnt(11)
    buffer_load_dwordx4 v[112:115], v1, s[4:7], s67 offen offset:2048 nt
    v_mfma_f32_16x16x32_bf16 v[28:31], v[120:123], v[4:7], 0
    v_mov_b32_dpp v34, v24 quad_perm:[0,0,0,0] row_mask:0xf bank_mask:0xf
    s_nop 1
    v_add_f32_dpp v34, v25, v34 quad_perm:[1,1,1,1] row_mask:0xf bank_mask:0xf
    s_nop 1
    v_add_f32_dpp v34, v26, v34 quad_perm:[2,2,2,2] row_mask:0xf bank_mask:0xf
    s_nop 1
    v_add_f32_dpp v34, v27, v34 quad_perm:[3,3,3,3] row_mask:0xf bank_mask:0xf
    s_waitcnt vmcnt(11)
    buffer_load_dwordx4 v[116:119], v1, s[4:7], s67 offen offset:256 nt
    v_mfma_f32_16x16x32_bf16 v[24:27], v[60:63], v[4:7], 0
    v_mov_b32_dpp v35, v28 quad_perm:[0,0,0,0] row_mask:0xf bank_mask:0xf
    s_nop 1
    v_add_f32_dpp v35, v29, v35 quad_perm:[1,1,1,1] row_mask:0xf bank_mask:0xf
    s_nop 1
    v_add_f32_dpp v35, v30, v35 quad_perm:[2,2,2,2] row_mask:0xf bank_mask:0xf
    s_nop 1
    v_add_f32_dpp v35, v31, v35 quad_perm:[3,3,3,3] row_mask:0xf bank_mask:0xf
    ds_write_b128 v3, v[32:35] offset:768
    v_max3_f32 v16, v16, v32, v33
    v_max3_f32 v16, v16, v34, v35
    v_add_u32 v3, 1024, v3
    s_waitcnt vmcnt(11)
    buffer_load_dwordx4 v[120:123], v1, s[4:7], s67 offen offset:2304 nt
    s_add_u32 s21, s21, 1
    s_ff1_i32_b32 m0, s21
    s_nop 0
    s_movrels_b32 s67, s72
    s_xor_b32 s20, s20, s67
    s_cmp_lg_u32 s21, s60
    s_cbranch_scc1 L_loop1_3
    s_branch L_ctl1
L_loop1_0:
    v_mfma_f32_16x16x32_bf16 v[28:31], v[64:67], v[4:7], 0
    v_mov_b32_dpp v32, v24 quad_perm:[0,0,0,0] row_mask:0xf bank_mask:0xf
    s_nop 1
    v_add_f32_dpp v32, v25, v32 quad_perm:[1,1,1,1] row_mask:0xf bank_mask:0xf
    s_nop 1
    v_add_f32_dpp v32, v26, v32 quad_perm:[2,2,2,2] row_mask:0xf bank_mask:0xf
    s_nop 1
    v_add_f32_dpp v32, v27, v32 quad_perm:[3,3,3,3] row_mask:0xf bank_mask:0xf
    s_waitcnt vmcnt(8)
    buffer_load_dwordx4 v[60:63], v1, s[4:7], s20 offen offset:0 nt
    v_mfma_f32_16x16x32_bf16 v[24:27], v[68:71], v[4:7], 0
    v_mov_b32_dpp v33, v28 quad_perm:[0,0,0,0] row_mask:0xf bank_mask:0xf
    s_nop 1
    v_add_f32_dpp v33, v29, v33 quad_perm:[1,1,1,1] row_mask:0xf bank_mask:0xf
    s_nop 1
    v_add_f32_dpp v33, v30, v33 quad_perm:[2,2,2,2] row_mask:0xf bank_mask:0xf
    s_nop 1
    v_add_f32_dpp v33, v31, v33 quad_perm:[3,3,3,3] row_mask:0xf bank_mask:0xf
    s_waitcnt vmcnt(8)
    buffer_load_dwordx4 v[64:67], v1, s[4:7], s20 offen offset:2048 nt
    v_mfma_f32_16x16x32_bf16 v[28:31], v[72:75], v[4:7], 0
    v_mov_b32_dpp v34, v24 quad_perm:[0,0,0,0] row_mask:0xf bank_mask:0xf
    s_nop 1
    v_add_f32_dpp v34, v25, v34 quad_perm:[1,1,1,1] row_mask:0xf bank_mask:0xf
    s_nop 1
    v_add_f32_dpp v34, v26, v34 quad_perm:[2,2,2,2] row_mask:0xf bank_mask:0xf
    s_nop 1
    v_add_f32_dpp v34, v27, v34 quad_perm:[3,3,3,3] row_mask:0xf bank_mask:0xf
    s_waitcnt vmcnt(8)
    buffer_load_dwordx4 v[68:71], v1, s[4:7], s20 offen offset:256 nt
    v_mfma_f32_16x16x32_bf16 v[24:27], v[76:79], v[4:7], 0
    v_mov_b32_dpp v35, v28 quad_perm:[0,0,0,0] row_mask:0xf bank_mask:0xf
    s_nop 1
    v_add_f32_dpp v35, v29, v35 quad_perm:[1,1,1,1] row_mask:0xf bank_mask:0xf
    s_nop 1
    v_add_f32_dpp v35, v30, v35 quad_perm:[2,2,2,2] row_mask:0xf bank_mask:0xf
    s_nop 1
    v_add_f32_dpp v35, v31, v35 quad_perm:[3,3,3,3] row_mask:0xf bank_mask:0xf
    ds_write_b128 v3, v[32:35] offset:0
    v_max3_f32 v16, v16, v32, v33
    v_max3_f32 v16, v16, v34, v35
    s_waitcnt vmcnt(8)
    buffer_load_dwordx4 v[72:75], v1, s[4:7], s20 offen offset:2304 nt
    v_mfma_f32_16x16x32_bf16 v[28:31], v[80:83], v[4:7], 0
    v_mov_b32_dpp v32, v24 quad_perm:[0,0,0,0] row_mask:0xf bank_mask:0xf
    s_nop 1
    v_add_f32_dpp v32, v25, v32 quad_perm:[1,1,1,1] row_mask:0xf bank_mask:0xf
    s_nop 1
    v_add_f32_dpp v32, v26, v32 quad_perm:[2,2,2,2] row_mask:0xf bank_mask:0xf
    s_nop 1
    v_add_f32_dpp v32, v27, v32 quad_perm:[3,3,3,3] row_mask:0xf bank_mask:0xf
    s_xor_b32 s67, s20, 0x4000
    s_waitcnt vmcnt(8)
    buffer_load_dwordx4 v[76:79], v1, s[4:7], s67 offen offset:0 nt
    v_mfma_f32_16x16x32_bf16 v[24:27], v[84:87], v[4:7], 0
    v_mov_b32_dpp v33, v28 quad_perm:[0,0,0,0] row_mask:0xf bank_mask:0xf
    s_nop 1
    v_add_f32_dpp v33, v29, v33 quad_perm:[1,1,1,1] row_mask:0xf bank_mask:0xf
    s_nop 1
    v_add_f32_dpp v33, v30, v33 quad_perm:[2,2,2,2] row_mask:0xf bank_mask:0xf
    s_nop 1
    v_add_f32_dpp v33, v31, v33 quad_perm:[3,3,3,3] row_mask:0xf bank_mask:0xf
    s_waitcnt vmcnt(8)
    buffer_load_dwordx4 v[80:83], v1, s[4:7], s67 offen offset:2048 nt
    v_mfma_f32_16x16x32_bf16 v[28:31], v[88:91], v[4:7], 0
    v_mov_b32_dpp v34, v24 quad_perm:[0,0,0,0] row_mask:0xf bank_mask:0xf
    s_nop 1
    v_add_f32_dpp v34, v25, v34 quad_perm:[1,1,1,1] row_mask:0xf bank_mask:0xf
    s_nop 1
    v_add_f32_dpp v34, v26, v34 quad_perm:[2,2,2,2] row_mask:0xf bank_mask:0xf
    s_nop 1
    v_add_f32_dpp v34, v27, v34 quad_perm:[3,3,3,3] row_mask:0xf bank_mask:0xf
    s_waitcnt vmcnt(8)
    buffer_load_dwordx4 v[84:87], v1, s[4:7], s67 offen offset:256 nt
    v_mfma_f32_16x16x32_bf16 v[24:27], v[92:95], v[4:7], 0
    v_mov_b32_dpp v35, v28 quad_perm:[0,0,0,0] row_mask:0xf bank_mask:0xf
    s_nop 1
    v_add_f32_dpp v35, v29, v35 quad_perm:[1,1,1,1] row_mask:0xf bank_mask:0xf
    s_nop 1
    v_add_f32_dpp v35, v30, v35 quad_perm:[2,2,2,2] row_mask:0xf bank_mask:0xf
    s_nop 1
    v_add_f32_dpp v35, v31, v35 quad_perm:[3,3,3,3] row_mask:0xf bank_mask:0xf
    ds_write_b128 v3, v[32:35] offset:256
    v_max3_f32 v16, v16, v32, v33
    v_max3_f32 v16, v16, v34, v35
    s_waitcnt vmcnt(8)
    buffer_load_dwordx4 v[88:91], v1, s[4:7], s67 offen offset:2304 nt
    v_mfma_f32_16x16x32_bf16 v[28:31], v[96:99], v[4:7], 0
    v_mov_b32_dpp v32, v24 quad_perm:[0,0,0,0] row_mask:0xf bank_mask:0xf
    s_nop 1
    v_add_f32_dpp v32, v25, v32 quad_perm:[1,1,1,1] row_mask:0xf bank_mask:0xf
    s_nop 1
    v_add_f32_dpp v32, v26, v32 quad_perm:[2,2,2,2] row_mask:0xf bank_mask:0xf
    s_nop 1
    v_add_f32_dpp v32, v27, v32 quad_perm:[3,3,3,3] row_mask:0xf bank_mask:0xf
    s_xor_b32 s67, s20, 0x2000
    s_waitcnt vmcnt(8)
    buffer_load_dwordx4 v[92:95], v1, s[4:7], s67 offen offset:0 nt
    v_mfma_f32_16x16x32_bf16 v[24:27], v[100:103], v[4:7], 0
    v_mov_b32_dpp v33, v28 quad_perm:[0,0,0,0] row_mask:0xf bank_mask:0xf
    s_nop 1
    v_add_f32_dpp v33, v29, v33 quad_perm:[1,1,1,1] row_mask:0xf bank_mask:0xf
    s_nop 1
    v_add_f32_dpp v33, v30, v33 quad_perm:[2,2,2,2] row_mask:0xf bank_mask:0xf
    s_nop 1
    v_add_f32_dpp v33, v31, v33 quad_perm:[3,3,3,3] row_mask:0xf bank_mask:0xf
    s_waitcnt vmcnt(8)
    buffer_load_dwordx4 v[96:99], v1, s[4:7], s67 offen offset:2048 nt
    v_mfma_f32_16x16x32_bf16 v[28:31], v[104:107], v[4:7], 0
    v_mov_b32_dpp v34, v24 quad_perm:[0,0,0,0] row_mask:0xf bank_mask:0xf
    s_nop 1
    v_add_f32_dpp v34, v25, v34 quad_perm:[1,1,1,1] row_mask:0xf bank_mask:0xf
    s_nop 1
    v_add_f32_dpp v34, v26, v34 quad_perm:[2,2,2,2] row_mask:0xf bank_mask:0xf
    s_nop 1
    v_add_f32_dpp v34, v27, v34 quad_perm:[3,3,3,3] row_mask:0xf bank_mask:0xf
    s_waitcnt vmcnt(8)
    buffer_load_dwordx4 v[100:103], v1, s[4:7], s67 offen offset:256 nt
    v_mfma_f32_16x16x32_bf16 v[24:27], v[108:111], v[4:7], 0
    v_mov_b32_dpp v35, v28 quad_perm:[0,0,0,0] row_mask:0xf bank_mask:0xf
    s_nop 1
    v_add_f32_dpp v35, v29, v35 quad_perm:[1,1,1,1] row_mask:0xf bank_mask:0xf
    s_nop 1
    v_add_f32_dpp v35, v30, v35 quad_perm:[2,2,2,2] row_mask:0xf bank_mask:0xf
    s_nop 1
    v_add_f32_dpp v35, v31, v35 quad_perm:[3,3,3,3] row_mask:0xf bank_mask:0xf
    ds_write_b128 v3, v[32:35] offset:512
    v_max3_f32 v16, v16, v32, v33
    v_max3_f32 v16, v16, v34, v35
    s_waitcnt vmcnt(8)
    buffer_load_dwordx4 v[104:107], v1, s[4:7], s67 offen offset:2304 nt
    v_mfma_f32_16x16x32_bf16 v[28:31], v[112:115], v[4:7], 0
    v_mov_b32_dpp v32, v24 quad_perm:[0,0,0,0] row_mask:0xf bank_mask:0xf
    s_nop 1
    v_add_f32_dpp v32, v25, v32 quad_perm:[1,1,1,1] row_mask:0xf bank_mask:0xf
    s_nop 1
    v_add_f32_dpp v32, v26, v32 quad_perm:[2,2,2,2] row_mask:0xf bank_mask:0xf
    s_nop 1
    v_add_f32_dpp v32, v27, v32 quad_perm:[3,3,3,3] row_mask:0xf bank_mask:0xf
    s_xor_b32 s67, s20, 0x6000
    s_waitcnt vmcnt(8)
    buffer_load_dwordx4 v[108:111], v1, s[4:7], s67 offen offset:0 nt
    v_mfma_f32_16x16x32_bf16 v[24:27], v[116:119], v[4:7], 0
    v_mov_b32_dpp v33, v28 quad_perm:[0,0,0,0] row_mask:0xf bank_mask:0xf
    s_nop 1
    v_add_f32_dpp v33, v29, v33 quad_perm:[1,1,1,1] row_mask:0xf bank_mask:0xf
    s_nop 1
    v_add_f32_dpp v33, v30, v33 quad_perm:[2,2,2,2] row_mask:0xf bank_mask:0xf
    s_nop 1
    v_add_f32_dpp v33, v31, v33 quad_perm:[3,3,3,3] row_mask:0xf bank_mask:0xf
    s_waitcnt vmcnt(8)
    buffer_load_dwordx4 v[112:115], v1, s[4:7], s67 offen offset:2048 nt
    v_mfma_f32_16x16x32_bf16 v[28:31], v[120:123], v[4:7], 0
    v_mov_b32_dpp v34, v24 quad_perm:[0,0,0,0] row_mask:0xf bank_mask:0xf
    s_nop 1
    v_add_f32_dpp v34, v25, v34 quad_perm:[1,1,1,1] row_mask:0xf bank_mask:0xf
    s_nop 1
    v_add_f32_dpp v34, v26, v34 quad_perm:[2,2,2,2] row_mask:0xf bank_mask:0xf
    s_nop 1
    v_add_f32_dpp v34, v27, v34 quad_perm:[3,3,3,3] row_mask:0xf bank_mask:0xf
    s_waitcnt vmcnt(8)
    buffer_load_dwordx4 v[116:119], v1, s[4:7], s67 offen offset:256 nt
    v_mfma_f32_16x16x32_bf16 v[24:27], v[60:63], v[4:7], 0
    v_mov_b32_dpp v35, v28 quad_perm:[0,0,0,0] row_mask:0xf bank_mask:0xf
    s_nop 1
    v_add_f32_dpp v35, v29, v35 quad_perm:[1,1,1,1] row_mask:0xf bank_mask:0xf
    s_nop 1
    v_add_f32_dpp v35, v30, v35 quad_perm:[2,2,2,2] row_mask:0xf bank_mask:0xf
    s_nop 1
    v_add_f32_dpp v35, v31, v35 quad_perm:[3,3,3,3] row_mask:0xf bank_mask:0xf
    ds_write_b128 v3, v[32:35] offset:768
    v_max3_f32 v16, v16, v32, v33
    v_max3_f32 v16, v16, v34, v35
    v_add_u32 v3, 1024, v3
    s_waitcnt vmcnt(8)
    buffer_load_dwordx4 v[120:123], v1, s[4:7], s67 offen offset:2304 nt
    s_add_u32 s21, s21, 1
    s_ff1_i32_b32 m0, s21
    s_nop 0
    s_movrels_b32 s67, s72
    s_xor_b32 s20, s20, s67
    s_cmp_lg_u32 s21, s60
    s_cbranch_scc1 L_loop1_0
    s_branch L_ctl1
L_loop1_2:
    v_mfma_f32_16x16x32_bf16 v[28:31], v[64:67], v[4:7], 0
    v_mov_b32_dpp v32, v24 quad_perm:[0,0,0,0] row_mask:0xf bank_mask:0xf
    s_nop 1
    v_add_f32_dpp v32, v25, v32 quad_perm:[1,1,1,1] row_mask:0xf bank_mask:0xf
    s_nop 1
    v_add_f32_dpp v32, v26, v32 quad_perm:[2,2,2,2] row_mask:0xf bank_mask:0xf
    s_nop 1
    v_add_f32_dpp v32, v27, v32 quad_perm:[3,3,3,3] row_mask:0xf bank_mask:0xf
    s_waitcnt vmcnt(10)
    buffer_load_dwordx4 v[60:63], v1, s[4:7], s20 offen offset:0 nt
    v_mfma_f32_16x16x32_bf16 v[24:27], v[68:71], v[4:7], 0
    v_mov_b32_dpp v33, v28 quad_perm:[0,0,0,0] row_mask:0xf bank_mask:0xf
    s_nop 1
    v_add_f32_dpp v33, v29, v33 quad_perm:[1,1,1,1] row_mask:0xf bank_mask:0xf
    s_nop 1
    v_add_f32_dpp v33, v30, v33 quad_perm:[2,2,2,2] row_mask:0xf bank_mask:0xf
    s_nop 1
    v_add_f32_dpp v33, v31, v33 quad_perm:[3,3,3,3] row_mask:0xf bank_mask:0xf
    s_waitcnt vmcnt(10)
    buffer_load_dwordx4 v[64:67], v1, s[4:7], s20 offen offset:2048 nt
    v_mfma_f32_16x16x32_bf16 v[28:31], v[72:75], v[4:7], 0
    v_mov_b32_dpp v34, v24 quad_perm:[0,0,0,0] row_mask:0xf bank_mask:0xf
    s_nop 1
    v_add_f32_dpp v34, v25, v34 quad_perm:[1,1,1,1] row_mask:0xf bank_mask:0xf
    s_nop 1
    v_add_f32_dpp v34, v26, v34 quad_perm:[2,2,2,2] row_mask:0xf bank_mask:0xf
    s_nop 1
    v_add_f32_dpp v34, v27, v34 quad_perm:[3,3,3,3] row_mask:0xf bank_mask:0xf
    s_waitcnt vmcnt(10)
    buffer_load_dwordx4 v[68:71], v1, s[4:7], s20 offen offset:256 nt
    v_mfma_f32_16x16x32_bf16 v[24:27], v[76:79], v[4:7], 0
    v_mov_b32_dpp v35, v28 quad_perm:[0,0,0,0] row_mask:0xf bank_mask:0xf
    s_nop 1
    v_add_f32_dpp v35, v29, v35 quad_perm:[1,1,1,1] row_mask:0xf bank_mask:0xf
    s_nop 1
    v_add_f32_dpp v35, v30, v35 quad_perm:[2,2,2,2] row_mask:0xf bank_mask:0xf
    s_nop 1
    v_add_f32_dpp v35, v31, v35 quad_perm:[3,3,3,3] row_mask:0xf bank_mask:0xf
    ds_write_b128 v3, v[32:35] offset:0
    v_max3_f32 v16, v16, v32, v33
    v_max3_f32 v16, v16, v34, v35
    s_waitcnt vmcnt(10)
    buffer_load_dwordx4 v[72:75], v1, s[4:7], s20 offen offset:2304 nt
    v_mfma_f32_16x16x32_bf16 v[28:31], v[80:83], v[4:7], 0
    v_mov_b32_dpp v32, v24 quad_perm:[0,0,0,0] row_mask:0xf bank_mask:0xf
    s_nop 1
    v_add_f32_dpp v32, v25, v32 quad_perm:[1,1,1,1] row_mask:0xf bank_mask:0xf
    s_nop 1
    v_add_f32_dpp v32, v26, v32 quad_perm:[2,2,2,2] row_mask:0xf bank_mask:0xf
    s_nop 1
    v_add_f32_dpp v32, v27, v32 quad_perm:[3,3,3,3] row_mask:0xf bank_mask:0xf
    s_xor_b32 s67, s20, 0x4000
    s_waitcnt vmcnt(10)
    buffer_load_dwordx4 v[76:79], v1, s[4:7], s67 offen offset:0 nt
    v_mfma_f32_16x16x32_bf16 v[24:27], v[84:87], v[4:7], 0
    v_mov_b32_dpp v33, v28 quad_perm:[0,0,0,0] row_mask:0xf bank_mask:0xf
    s_nop 1
    v_add_f32_dpp v33, v29, v33 quad_perm:[1,1,1,1] row_mask:0xf bank_mask:0xf
    s_nop 1
    v_add_f32_dpp v33, v30, v33 quad_perm:[2,2,2,2] row_mask:0xf bank_mask:0xf
    s_nop 1
    v_add_f32_dpp v33, v31, v33 quad_perm:[3,3,3,3] row_mask:0xf bank_mask:0xf
    s_waitcnt vmcnt(10)
    buffer_load_dwordx4 v[80:83], v1, s[4:7], s67 offen offset:2048 nt
    v_mfma_f32_16x16x32_bf16 v[28:31], v[88:91], v[4:7], 0
    v_mov_b32_dpp v34, v24 quad_perm:[0,0,0,0] row_mask:0xf bank_mask:0xf
    s_nop 1
    v_add_f32_dpp v34, v25, v34 quad_perm:[1,1,1,1] row_mask:0xf bank_mask:0xf
    s_nop 1
    v_add_f32_dpp v34, v26, v34 quad_perm:[2,2,2,2] row_mask:0xf bank_mask:0xf
    s_nop 1
    v_add_f32_dpp v34, v27, v34 quad_perm:[3,3,3,3] row_mask:0xf bank_mask:0xf
    s_waitcnt vmcnt(10)
    buffer_load_dwordx4 v[84:87], v1, s[4:7], s67 offen offset:256 nt
    v_mfma_f32_16x16x32_bf16 v[24:27], v[92:95], v[4:7], 0
    v_mov_b32_dpp v35, v28 quad_perm:[0,0,0,0] row_mask:0xf bank_mask:0xf
    s_nop 1
    v_add_f32_dpp v35, v29, v35 quad_perm:[1,1,1,1] row_mask:0xf bank_mask:0xf
    s_nop 1
    v_add_f32_dpp v35, v30, v35 quad_perm:[2,2,2,2] row_mask:0xf bank_mask:0xf
    s_nop 1
    v_add_f32_dpp v35, v31, v35 quad_perm:[3,3,3,3] row_mask:0xf bank_mask:0xf
    ds_write_b128 v3, v[32:35] offset:256
    v_max3_f32 v16, v16, v32, v33
    v_max3_f32 v16, v16, v34, v35
    s_waitcnt vmcnt(10)
    buffer_load_dwordx4 v[88:91], v1, s[4:7], s67 offen offset:2304 nt
    v_mfma_f32_16x16x32_bf16 v[28:31], v[96:99], v[4:7], 0
    v_mov_b32_dpp v32, v24 quad_perm:[0,0,0,0] row_mask:0xf bank_mask:0xf
    s_nop 1
    v_add_f32_dpp v32, v25, v32 quad_perm:[1,1,1,1] row_mask:0xf bank_mask:0xf
    s_nop 1
    v_add_f32_dpp v32, v26, v32 quad_perm:[2,2,2,2] row_mask:0xf bank_mask:0xf
    s_nop 1
    v_add_f32_dpp v32, v27, v32 quad_perm:[3,3,3,3] row_mask:0xf bank_mask:0xf
    s_xor_b32 s67, s20, 0x2000
    s_waitcnt vmcnt(10)
    buffer_load_dwordx4 v[92:95], v1, s[4:7], s67 offen offset:0 nt
    v_mfma_f32_16x16x32_bf16 v[24:27], v[100:103], v[4:7], 0
    v_mov_b32_dpp v33, v28 quad_perm:[0,0,0,0] row_mask:0xf bank_mask:0xf
    s_nop 1
    v_add_f32_dpp v33, v29, v33 quad_perm:[1,1,1,1] row_mask:0xf bank_mask:0xf
    s_nop 1
    v_add_f32_dpp v33, v30, v33 quad_perm:[2,2,2,2] row_mask:0xf bank_mask:0xf
    s_nop 1
    v_add_f32_dpp v33, v31, v33 quad_perm:[3,3,3,3] row_mask:0xf bank_mask:0xf
    s_waitcnt vmcnt(10)
    buffer_load_dwordx4 v[96:99], v1, s[4:7], s67 offen offset:2048 nt
    v_mfma_f32_16x16x32_bf16 v[28:31], v[104:107], v[4:7], 0
    v_mov_b32_dpp v34, v24 quad_perm:[0,0,0,0] row_mask:0xf bank_mask:0xf
    s_nop 1
    v_add_f32_dpp v34, v25, v34 quad_perm:[1,1,1,1] row_mask:0xf bank_mask:0xf
    s_nop 1
    v_add_f32_dpp v34, v26, v34 quad_perm:[2,2,2,2] row_mask:0xf bank_mask:0xf
    s_nop 1
    v_add_f32_dpp v34, v27, v34 quad_perm:[3,3,3,3] row_mask:0xf bank_mask:0xf
    s_waitcnt vmcnt(10)
    buffer_load_dwordx4 v[100:103], v1, s[4:7], s67 offen offset:256 nt
    v_mfma_f32_16x16x32_bf16 v[24:27], v[108:111], v[4:7], 0
    v_mov_b32_dpp v35, v28 quad_perm:[0,0,0,0] row_mask:0xf bank_mask:0xf
    s_nop 1
    v_add_f32_dpp v35, v29, v35 quad_perm:[1,1,1,1] row_mask:0xf bank_mask:0xf
    s_nop 1
    v_add_f32_dpp v35, v30, v35 quad_perm:[2,2,2,2] row_mask:0xf bank_mask:0xf
    s_nop 1
    v_add_f32_dpp v35, v31, v35 quad_perm:[3,3,3,3] row_mask:0xf bank_mask:0xf
    ds_write_b128 v3, v[32:35] offset:512
    v_max3_f32 v16, v16, v32, v33
    v_max3_f32 v16, v16, v34, v35
    s_waitcnt vmcnt(10)
    buffer_load_dwordx4 v[104:107], v1, s[4:7], s67 offen offset:2304 nt
    v_mfma_f32_16x16x32_bf16 v[28:31], v[112:115], v[4:7], 0
    v_mov_b32_dpp v32, v24 quad_perm:[0,0,0,0] row_mask:0xf bank_mask:0xf
    s_nop 1
    v_add_f32_dpp v32, v25, v32 quad_perm:[1,1,1,1] row_mask:0xf bank_mask:0xf
    s_nop 1
    v_add_f32_dpp v32, v26, v32 quad_perm:[2,2,2,2] row_mask:0xf bank_mask:0xf
    s_nop 1
    v_add_f32_dpp v32, v27, v32 quad_perm:[3,3,3,3] row_mask:0xf bank_mask:0xf
    s_xor_b32 s67, s20, 0x6000
    s_waitcnt vmcnt(10)
    buffer_load_dwordx4 v[108:111], v1, s[4:7], s67 offen offset:0 nt
    v_mfma_f32_16x16x32_bf16 v[24:27], v[116:119], v[4:7], 0
    v_mov_b32_dpp v33, v28 quad_perm:[0,0,0,0] row_mask:0xf bank_mask:0xf
    s_nop 1
    v_add_f32_dpp v33, v29, v33 quad_perm:[1,1,1,1] row_mask:0xf bank_mask:0xf
    s_nop 1
    v_add_f32_dpp v33, v30, v33 quad_perm:[2,2,2,2] row_mask:0xf bank_mask:0xf
    s_nop 1
    v_add_f32_dpp v33, v31, v33 quad_perm:[3,3,3,3] row_mask:0xf bank_mask:0xf
    s_waitcnt vmcnt(10)
    buffer_load_dwordx4 v[112:115], v1, s[4:7], s67 offen offset:2048 nt
    v_mfma_f32_16x16x32_bf16 v[28:31], v[120:123], v[4:7], 0
    v_mov_b32_dpp v34, v24 quad_perm:[0,0,0,0] row_mask:0xf bank_mask:0xf
    s_nop 1
    v_add_f32_dpp v34, v25, v34 quad_perm:[1,1,1,1] row_mask:0xf bank_mask:0xf
    s_nop 1
    v_add_f32_dpp v34, v26, v34 quad_perm:[2,2,2,2] row_mask:0xf bank_mask:0xf
    s_nop 1
    v_add_f32_dpp v34, v27, v34 quad_perm:[3,3,3,3] row_mask:0xf bank_mask:0xf
    s_waitcnt vmcnt(10)
    buffer_load_dwordx4 v[116:119], v1, s[4:7], s67 offen offset:256 nt
    v_mfma_f32_16x16x32_bf16 v[24:27], v[60:63], v[4:7], 0
    v_mov_b32_dpp v35, v28 quad_perm:[0,0,0,0] row_mask:0xf bank_mask:0xf
    s_nop 1
    v_add_f32_dpp v35, v29, v35 quad_perm:[1,1,1,1] row_mask:0xf bank_mask:0xf
    s_nop 1
    v_add_f32_dpp v35, v30, v35 quad_perm:[2,2,2,2] row_mask:0xf bank_mask:0xf
    s_nop 1
    v_add_f32_dpp v35, v31, v35 quad_perm:[3,3,3,3] row_mask:0xf bank_mask:0xf
    ds_write_b128 v3, v[32:35] offset:768
    v_max3_f32 v16, v16, v32, v33
    v_max3_f32 v16, v16, v34, v35
    v_add_u32 v3, 1024, v3
    s_waitcnt vmcnt(10)
    buffer_load_dwordx4 v[120:123], v1, s[4:7], s67 offen offset:2304 nt
    s_add_u32 s21, s21, 1
    s_ff1_i32_b32 m0, s21
    s_nop 0
    s_movrels_b32 s67, s72
    s_xor_b32 s20, s20, s67
    s_cmp_lg_u32 s21, s60
    s_cbranch_scc1 L_loop1_2
    s_branch L_ctl1
L_loop1_4:
    v_mfma_f32_16x16x32_bf16 v[28:31], v[64:67], v[4:7], 0
    v_mov_b32_dpp v32, v24 quad_perm:[0,0,0,0] row_mask:0xf bank_mask:0xf
    s_nop 1
    v_add_f32_dpp v32, v25, v32 quad_perm:[1,1,1,1] row_mask:0xf bank_mask:0xf
    s_nop 1
    v_add_f32_dpp v32, v26, v32 quad_perm:[2,2,2,2] row_mask:0xf bank_mask:0xf
    s_nop 1
    v_add_f32_dpp v32, v27, v32 quad_perm:[3,3,3,3] row_mask:0xf bank_mask:0xf
    s_waitcnt vmcnt(12)
    buffer_load_dwordx4 v[60:63], v1, s[4:7], s20 offen offset:0 nt
    v_mfma_f32_16x16x32_bf16 v[24:27], v[68:71], v[4:7], 0
    v_mov_b32_dpp v33, v28 quad_perm:[0,0,0,0] row_mask:0xf bank_mask:0xf
    s_nop 1
    v_add_f32_dpp v33, v29, v33 quad_perm:[1,1,1,1] row_mask:0xf bank_mask:0xf
    s_nop 1
    v_add_f32_dpp v33, v30, v33 quad_perm:[2,2,2,2] row_mask:0xf bank_mask:0xf
    s_nop 1
    v_add_f32_dpp v33, v31, v33 quad_perm:[3,3,3,3] row_mask:0xf bank_mask:0xf
    s_waitcnt vmcnt(12)
    buffer_load_dwordx4 v[64:67], v1, s[4:7], s20 offen offset:2048 nt
    v_mfma_f32_16x16x32_bf16 v[28:31], v[72:75], v[4:7], 0
    v_mov_b32_dpp v34, v24 quad_perm:[0,0,0,0] row_mask:0xf bank_mask:0xf
    s_nop 1
    v_add_f32_dpp v34, v25, v34 quad_perm:[1,1,1,1] row_mask:0xf bank_mask:0xf
    s_nop 1
    v_add_f32_dpp v34, v26, v34 quad_perm:[2,2,2,2] row_mask:0xf bank_mask:0xf
    s_nop 1
    v_add_f32_dpp v34, v27, v34 quad_perm:[3,3,3,3] row_mask:0xf bank_mask:0xf
    s_waitcnt vmcnt(12)
    buffer_load_dwordx4 v[68:71], v1, s[4:7], s20 offen offset:256 nt
    v_mfma_f32_16x16x32_bf16 v[24:27], v[76:79], v[4:7], 0
    v_mov_b32_dpp v35, v28 quad_perm:[0,0,0,0] row_mask:0xf bank_mask:0xf
    s_nop 1
    v_add_f32_dpp v35, v29, v35 quad_perm:[1,1,1,1] row_mask:0xf bank_mask:0xf
    s_nop 1
    v_add_f32_dpp v35, v30, v35 quad_perm:[2,2,2,2] row_mask:0xf bank_mask:0xf
    s_nop 1
    v_add_f32_dpp v35, v31, v35 quad_perm:[3,3,3,3] row_mask:0xf bank_mask:0xf
    ds_write_b128 v3, v[32:35] offset:0
    v_max3_f32 v16, v16, v32, v33
    v_max3_f32 v16, v16, v34, v35
    s_waitcnt vmcnt(12)
    buffer_load_dwordx4 v[72:75], v1, s[4:7], s20 offen offset:2304 nt
    v_mfma_f32_16x16x32_bf16 v[28:31], v[80:83], v[4:7], 0
    v_mov_b32_dpp v32, v24 quad_perm:[0,0,0,0] row_mask:0xf bank_mask:0xf
    s_nop 1
    v_add_f32_dpp v32, v25, v32 quad_perm:[1,1,1,1] row_mask:0xf bank_mask:0xf
    s_nop 1
    v_add_f32_dpp v32, v26, v32 quad_perm:[2,2,2,2] row_mask:0xf bank_mask:0xf
    s_nop 1
    v_add_f32_dpp v32, v27, v32 quad_perm:[3,3,3,3] row_mask:0xf bank_mask:0xf
    s_xor_b32 s67, s20, 0x4000
    s_waitcnt vmcnt(12)
    buffer_load_dwordx4 v[76:79], v1, s[4:7], s67 offen offset:0 nt
    v_mfma_f32_16x16x32_bf16 v[24:27], v[84:87], v[4:7], 0
    v_mov_b32_dpp v33, v28 quad_perm:[0,0,0,0] row_mask:0xf bank_mask:0xf
    s_nop 1
    v_add_f32_dpp v33, v29, v33 quad_perm:[1,1,1,1] row_mask:0xf bank_mask:0xf
    s_nop 1
    v_add_f32_dpp v33, v30, v33 quad_perm:[2,2,2,2] row_mask:0xf bank_mask:0xf
    s_nop 1
    v_add_f32_dpp v33, v31, v33 quad_perm:[3,3,3,3] row_mask:0xf bank_mask:0xf
    s_waitcnt vmcnt(12)
    buffer_load_dwordx4 v[80:83], v1, s[4:7], s67 offen offset:2048 nt
    v_mfma_f32_16x16x32_bf16 v[28:31], v[88:91], v[4:7], 0
    v_mov_b32_dpp v34, v24 quad_perm:[0,0,0,0] row_mask:0xf bank_mask:0xf
    s_nop 1
    v_add_f32_dpp v34, v25, v34 quad_perm:[1,1,1,1] row_mask:0xf bank_mask:0xf
    s_nop 1
    v_add_f32_dpp v34, v26, v34 quad_perm:[2,2,2,2] row_mask:0xf bank_mask:0xf
    s_nop 1
    v_add_f32_dpp v34, v27, v34 quad_perm:[3,3,3,3] row_mask:0xf bank_mask:0xf
    s_waitcnt vmcnt(12)
    buffer_load_dwordx4 v[84:87], v1, s[4:7], s67 offen offset:256 nt
    v_mfma_f32_16x16x32_bf16 v[24:27], v[92:95], v[4:7], 0
    v_mov_b32_dpp v35, v28 quad_perm:[0,0,0,0] row_mask:0xf bank_mask:0xf
    s_nop 1
    v_add_f32_dpp v35, v29, v35 quad_perm:[1,1,1,1] row_mask:0xf bank_mask:0xf
    s_nop 1
    v_add_f32_dpp v35, v30, v35 quad_perm:[2,2,2,2] row_mask:0xf bank_mask:0xf
    s_nop 1
    v_add_f32_dpp v35, v31, v35 quad_perm:[3,3,3,3] row_mask:0xf bank_mask:0xf
    ds_write_b128 v3, v[32:35] offset:256
    v_max3_f32 v16, v16, v32, v33
    v_max3_f32 v16, v16, v34, v35
    s_waitcnt vmcnt(12)
    buffer_load_dwordx4 v[88:91], v1, s[4:7], s67 offen offset:2304 nt
    v_mfma_f32_16x16x32_bf16 v[28:31], v[96:99], v[4:7], 0
    v_mov_b32_dpp v32, v24 quad_perm:[0,0,0,0] row_mask:0xf bank_mask:0xf
    s_nop 1
    v_add_f32_dpp v32, v25, v32 quad_perm:[1,1,1,1] row_mask:0xf bank_mask:0xf
    s_nop 1
    v_add_f32_dpp v32, v26, v32 quad_perm:[2,2,2,2] row_mask:0xf bank_mask:0xf
    s_nop 1
    v_add_f32_dpp v32, v27, v32 quad_perm:[3,3,3,3] row_mask:0xf bank_mask:0xf
    s_xor_b32 s67, s20, 0x2000
    s_waitcnt vmcnt(12)
    buffer_load_dwordx4 v[92:95], v1, s[4:7], s67 offen offset:0 nt
    v_mfma_f32_16x16x32_bf16 v[24:27], v[100:103], v[4:7], 0
    v_mov_b32_dpp v33, v28 quad_perm:[0,0,0,0] row_mask:0xf bank_mask:0xf
    s_nop 1
    v_add_f32_dpp v33, v29, v33 quad_perm:[1,1,1,1] row_mask:0xf bank_mask:0xf
    s_nop 1
    v_add_f32_dpp v33, v30, v33 quad_perm:[2,2,2,2] row_mask:0xf bank_mask:0xf
    s_nop 1
    v_add_f32_dpp v33, v31, v33 quad_perm:[3,3,3,3] row_mask:0xf bank_mask:0xf
    s_waitcnt vmcnt(12)
    buffer_load_dwordx4 v[96:99], v1, s[4:7], s67 offen offset:2048 nt
    v_mfma_f32_16x16x32_bf16 v[28:31], v[104:107], v[4:7], 0
    v_mov_b32_dpp v34, v24 quad_perm:[0,0,0,0] row_mask:0xf bank_mask:0xf
    s_nop 1
    v_add_f32_dpp v34, v25, v34 quad_perm:[1,1,1,1] row_mask:0xf bank_mask:0xf
    s_nop 1
    v_add_f32_dpp v34, v26, v34 quad_perm:[2,2,2,2] row_mask:0xf bank_mask:0xf
    s_nop 1
    v_add_f32_dpp v34, v27, v34 quad_perm:[3,3,3,3] row_mask:0xf bank_mask:0xf
    s_waitcnt vmcnt(12)
    buffer_load_dwordx4 v[100:103], v1, s[4:7], s67 offen offset:256 nt
    v_mfma_f32_16x16x32_bf16 v[24:27], v[108:111], v[4:7], 0
    v_mov_b32_dpp v35, v28 quad_perm:[0,0,0,0] row_mask:0xf bank_mask:0xf
    s_nop 1
    v_add_f32_dpp v35, v29, v35 quad_perm:[1,1,1,1] row_mask:0xf bank_mask:0xf
    s_nop 1
    v_add_f32_dpp v35, v30, v35 quad_perm:[2,2,2,2] row_mask:0xf bank_mask:0xf
    s_nop 1
    v_add_f32_dpp v35, v31, v35 quad_perm:[3,3,3,3] row_mask:0xf bank_mask:0xf
    ds_write_b128 v3, v[32:35] offset:512
    v_max3_f32 v16, v16, v32, v33
    v_max3_f32 v16, v16, v34, v35
    s_waitcnt vmcnt(12)
    buffer_load_dwordx4 v[104:107], v1, s[4:7], s67 offen offset:2304 nt
    v_mfma_f32_16x16x32_bf16 v[28:31], v[112:115], v[4:7], 0
    v_mov_b32_dpp v32, v24 quad_perm:[0,0,0,0] row_mask:0xf bank_mask:0xf
    s_nop 1
    v_add_f32_dpp v32, v25, v32 quad_perm:[1,1,1,1] row_mask:0xf bank_mask:0xf
    s_nop 1
    v_add_f32_dpp v32, v26, v32 quad_perm:[2,2,2,2] row_mask:0xf bank_mask:0xf
    s_nop 1
    v_add_f32_dpp v32, v27, v32 quad_perm:[3,3,3,3] row_mask:0xf bank_mask:0xf
    s_xor_b32 s67, s20, 0x6000
    s_waitcnt vmcnt(12)
    buffer_load_dwordx4 v[108:111], v1, s[4:7], s67 offen offset:0 nt
    v_mfma_f32_16x16x32_bf16 v[24:27], v[116:119], v[4:7], 0
    v_mov_b32_dpp v33, v28 quad_perm:[0,0,0,0] row_mask:0xf bank_mask:0xf
    s_nop 1
    v_add_f32_dpp v33, v29, v33 quad_perm:[1,1,1,1] row_mask:0xf bank_mask:0xf
    s_nop 1
    v_add_f32_dpp v33, v30, v33 quad_perm:[2,2,2,2] row_mask:0xf bank_mask:0xf
    s_nop 1
    v_add_f32_dpp v33, v31, v33 quad_perm:[3,3,3,3] row_mask:0xf bank_mask:0xf
    s_waitcnt vmcnt(12)
    buffer_load_dwordx4 v[112:115], v1, s[4:7], s67 offen offset:2048 nt
    v_mfma_f32_16x16x32_bf16 v[28:31], v[120:123], v[4:7], 0
    v_mov_b32_dpp v34, v24 quad_perm:[0,0,0,0] row_mask:0xf bank_mask:0xf
    s_nop 1
    v_add_f32_dpp v34, v25, v34 quad_perm:[1,1,1,1] row_mask:0xf bank_mask:0xf
    s_nop 1
    v_add_f32_dpp v34, v26, v34 quad_perm:[2,2,2,2] row_mask:0xf bank_mask:0xf
    s_nop 1
    v_add_f32_dpp v34, v27, v34 quad_perm:[3,3,3,3] row_mask:0xf bank_mask:0xf
    s_waitcnt vmcnt(12)
    buffer_load_dwordx4 v[116:119], v1, s[4:7], s67 offen offset:256 nt
    v_mfma_f32_16x16x32_bf16 v[24:27], v[60:63], v[4:7], 0
    v_mov_b32_dpp v35, v28 quad_perm:[0,0,0,0] row_mask:0xf bank_mask:0xf
    s_nop 1
    v_add_f32_dpp v35, v29, v35 quad_perm:[1,1,1,1] row_mask:0xf bank_mask:0xf
    s_nop 1
    v_add_f32_dpp v35, v30, v35 quad_perm:[2,2,2,2] row_mask:0xf bank_mask:0xf
    s_nop 1
    v_add_f32_dpp v35, v31, v35 quad_perm:[3,3,3,3] row_mask:0xf bank_mask:0xf
    ds_write_b128 v3, v[32:35] offset:768
    v_max3_f32 v16, v16, v32, v33
    v_max3_f32 v16, v16, v34, v35
    v_add_u32 v3, 1024, v3
    s_waitcnt vmcnt(12)
    buffer_load_dwordx4 v[120:123], v1, s[4:7], s67 offen offset:2304 nt
    s_add_u32 s21, s21, 1
    s_ff1_i32_b32 m0, s21
    s_nop 0
    s_movrels_b32 s67, s72
    s_xor_b32 s20, s20, s67
    s_cmp_lg_u32 s21, s60
    s_cbranch_scc1 L_loop1_4
    s_branch L_ctl1
L_loop1_5:
    v_mfma_f32_16x16x32_bf16 v[28:31], v[64:67], v[4:7], 0
    v_mov_b32_dpp v32, v24 quad_perm:[0,0,0,0] row_mask:0xf bank_mask:0xf
    s_nop 1
    v_add_f32_dpp v32, v25, v32 quad_perm:[1,1,1,1] row_mask:0xf bank_mask:0xf
    s_nop 1
    v_add_f32_dpp v32, v26, v32 quad_perm:[2,2,2,2] row_mask:0xf bank_mask:0xf
    s_nop 1
    v_add_f32_dpp v32, v27, v32 quad_perm:[3,3,3,3] row_mask:0xf bank_mask:0xf
    s_waitcnt vmcnt(13)
    buffer_load_dwordx4 v[60:63], v1, s[4:7], s20 offen offset:0 nt
    v_mfma_f32_16x16x32_bf16 v[24:27], v[68:71], v[4:7], 0
    v_mov_b32_dpp v33, v28 quad_perm:[0,0,0,0] row_mask:0xf bank_mask:0xf
    s_nop 1
    v_add_f32_dpp v33, v29, v33 quad_perm:[1,1,1,1] row_mask:0xf bank_mask:0xf
    s_nop 1
    v_add_f32_dpp v33, v30, v33 quad_perm:[2,2,2,2] row_mask:0xf bank_mask:0xf
    s_nop 1
    v_add_f32_dpp v33, v31, v33 quad_perm:[3,3,3,3] row_mask:0xf bank_mask:0xf
    s_waitcnt vmcnt(13)
    buffer_load_dwordx4 v[64:67], v1, s[4:7], s20 offen offset:2048 nt
    v_mfma_f32_16x16x32_bf16 v[28:31], v[72:75], v[4:7], 0
    v_mov_b32_dpp v34, v24 quad_perm:[0,0,0,0] row_mask:0xf bank_mask:0xf
    s_nop 1
    v_add_f32_dpp v34, v25, v34 quad_perm:[1,1,1,1] row_mask:0xf bank_mask:0xf
    s_nop 1
    v_add_f32_dpp v34, v26, v34 quad_perm:[2,2,2,2] row_mask:0xf bank_mask:0xf
    s_nop 1
    v_add_f32_dpp v34, v27, v34 quad_perm:[3,3,3,3] row_mask:0xf bank_mask:0xf
    s_waitcnt vmcnt(13)
    buffer_load_dwordx4 v[68:71], v1, s[4:7], s20 offen offset:256 nt
    v_mfma_f32_16x16x32_bf16 v[24:27], v[76:79], v[4:7], 0
    v_mov_b32_dpp v35, v28 quad_perm:[0,0,0,0] row_mask:0xf bank_mask:0xf
    s_nop 1
    v_add_f32_dpp v35, v29, v35 quad_perm:[1,1,1,1] row_mask:0xf bank_mask:0xf
    s_nop 1
    v_add_f32_dpp v35, v30, v35 quad_perm:[2,2,2,2] row_mask:0xf bank_mask:0xf
    s_nop 1
    v_add_f32_dpp v35, v31, v35 quad_perm:[3,3,3,3] row_mask:0xf bank_mask:0xf
    ds_write_b128 v3, v[32:35] offset:0
    v_max3_f32 v16, v16, v32, v33
    v_max3_f32 v16, v16, v34, v35
    s_waitcnt vmcnt(13)
    buffer_load_dwordx4 v[72:75], v1, s[4:7], s20 offen offset:2304 nt
    v_mfma_f32_16x16x32_bf16 v[28:31], v[80:83], v[4:7], 0
    v_mov_b32_dpp v32, v24 quad_perm:[0,0,0,0] row_mask:0xf bank_mask:0xf
    s_nop 1
    v_add_f32_dpp v32, v25, v32 quad_perm:[1,1,1,1] row_mask:0xf bank_mask:0xf
    s_nop 1
    v_add_f32_dpp v32, v26, v32 quad_perm:[2,2,2,2] row_mask:0xf bank_mask:0xf
    s_nop 1
    v_add_f32_dpp v32, v27, v32 quad_perm:[3,3,3,3] row_mask:0xf bank_mask:0xf
    s_xor_b32 s67, s20, 0x4000
    s_waitcnt vmcnt(13)
    buffer_load_dwordx4 v[76:79], v1, s[4:7], s67 offen offset:0 nt
    v_mfma_f32_16x16x32_bf16 v[24:27], v[84:87], v[4:7], 0
    v_mov_b32_dpp v33, v28 quad_perm:[0,0,0,0] row_mask:0xf bank_mask:0xf
    s_nop 1
    v_add_f32_dpp v33, v29, v33 quad_perm:[1,1,1,1] row_mask:0xf bank_mask:0xf
    s_nop 1
    v_add_f32_dpp v33, v30, v33 quad_perm:[2,2,2,2] row_mask:0xf bank_mask:0xf
    s_nop 1
    v_add_f32_dpp v33, v31, v33 quad_perm:[3,3,3,3] row_mask:0xf bank_mask:0xf
    s_waitcnt vmcnt(13)
    buffer_load_dwordx4 v[80:83], v1, s[4:7], s67 offen offset:2048 nt
    v_mfma_f32_16x16x32_bf16 v[28:31], v[88:91], v[4:7], 0
    v_mov_b32_dpp v34, v24 quad_perm:[0,0,0,0] row_mask:0xf bank_mask:0xf
    s_nop 1
    v_add_f32_dpp v34, v25, v34 quad_perm:[1,1,1,1] row_mask:0xf bank_mask:0xf
    s_nop 1
    v_add_f32_dpp v34, v26, v34 quad_perm:[2,2,2,2] row_mask:0xf bank_mask:0xf
    s_nop 1
    v_add_f32_dpp v34, v27, v34 quad_perm:[3,3,3,3] row_mask:0xf bank_mask:0xf
    s_waitcnt vmcnt(13)
    buffer_load_dwordx4 v[84:87], v1, s[4:7], s67 offen offset:256 nt
    v_mfma_f32_16x16x32_bf16 v[24:27], v[92:95], v[4:7], 0
    v_mov_b32_dpp v35, v28 quad_perm:[0,0,0,0] row_mask:0xf bank_mask:0xf
    s_nop 1
    v_add_f32_dpp v35, v29, v35 quad_perm:[1,1,1,1] row_mask:0xf bank_mask:0xf
    s_nop 1
    v_add_f32_dpp v35, v30, v35 quad_perm:[2,2,2,2] row_mask:0xf bank_mask:0xf
    s_nop 1
    v_add_f32_dpp v35, v31, v35 quad_perm:[3,3,3,3] row_mask:0xf bank_mask:0xf
    ds_write_b128 v3, v[32:35] offset:256
    v_max3_f32 v16, v16, v32, v33
    v_max3_f32 v16, v16, v34, v35
    s_waitcnt vmcnt(13)
    buffer_load_dwordx4 v[88:91], v1, s[4:7], s67 offen offset:2304 nt
    v_mfma_f32_16x16x32_bf16 v[28:31], v[96:99], v[4:7], 0
    v_mov_b32_dpp v32, v24 quad_perm:[0,0,0,0] row_mask:0xf bank_mask:0xf
    s_nop 1
    v_add_f32_dpp v32, v25, v32 quad_perm:[1,1,1,1] row_mask:0xf bank_mask:0xf
    s_nop 1
    v_add_f32_dpp v32, v26, v32 quad_perm:[2,2,2,2] row_mask:0xf bank_mask:0xf
    s_nop 1
    v_add_f32_dpp v32, v27, v32 quad_perm:[3,3,3,3] row_mask:0xf bank_mask:0xf
    s_xor_b32 s67, s20, 0x2000
    s_waitcnt vmcnt(13)
    buffer_load_dwordx4 v[92:95], v1, s[4:7], s67 offen offset:0 nt
    v_mfma_f32_16x16x32_bf16 v[24:27], v[100:103], v[4:7], 0
    v_mov_b32_dpp v33, v28 quad_perm:[0,0,0,0] row_mask:0xf bank_mask:0xf
    s_nop 1
    v_add_f32_dpp v33, v29, v33 quad_perm:[1,1,1,1] row_mask:0xf bank_mask:0xf
    s_nop 1
    v_add_f32_dpp v33, v30, v33 quad_perm:[2,2,2,2] row_mask:0xf bank_mask:0xf
    s_nop 1
    v_add_f32_dpp v33, v31, v33 quad_perm:[3,3,3,3] row_mask:0xf bank_mask:0xf
    s_waitcnt vmcnt(13)
    buffer_load_dwordx4 v[96:99], v1, s[4:7], s67 offen offset:2048 nt
    v_mfma_f32_16x16x32_bf16 v[28:31], v[104:107], v[4:7], 0
    v_mov_b32_dpp v34, v24 quad_perm:[0,0,0,0] row_mask:0xf bank_mask:0xf
    s_nop 1
    v_add_f32_dpp v34, v25, v34 quad_perm:[1,1,1,1] row_mask:0xf bank_mask:0xf
    s_nop 1
    v_add_f32_dpp v34, v26, v34 quad_perm:[2,2,2,2] row_mask:0xf bank_mask:0xf
    s_nop 1
    v_add_f32_dpp v34, v27, v34 quad_perm:[3,3,3,3] row_mask:0xf bank_mask:0xf
    s_waitcnt vmcnt(13)
    buffer_load_dwordx4 v[100:103], v1, s[4:7], s67 offen offset:256 nt
    v_mfma_f32_16x16x32_bf16 v[24:27], v[108:111], v[4:7], 0
    v_mov_b32_dpp v35, v28 quad_perm:[0,0,0,0] row_mask:0xf bank_mask:0xf
    s_nop 1
    v_add_f32_dpp v35, v29, v35 quad_perm:[1,1,1,1] row_mask:0xf bank_mask:0xf
    s_nop 1
    v_add_f32_dpp v35, v30, v35 quad_perm:[2,2,2,2] row_mask:0xf bank_mask:0xf
    s_nop 1
    v_add_f32_dpp v35, v31, v35 quad_perm:[3,3,3,3] row_mask:0xf bank_mask:0xf
    ds_write_b128 v3, v[32:35] offset:512
    v_max3_f32 v16, v16, v32, v33
    v_max3_f32 v16, v16, v34, v35
    s_waitcnt vmcnt(13)
    buffer_load_dwordx4 v[104:107], v1, s[4:7], s67 offen offset:2304 nt
    v_mfma_f32_16x16x32_bf16 v[28:31], v[112:115], v[4:7], 0
    v_mov_b32_dpp v32, v24 quad_perm:[0,0,0,0] row_mask:0xf bank_mask:0xf
    s_nop 1
    v_add_f32_dpp v32, v25, v32 quad_perm:[1,1,1,1] row_mask:0xf bank_mask:0xf
    s_nop 1
    v_add_f32_dpp v32, v26, v32 quad_perm:[2,2,2,2] row_mask:0xf bank_mask:0xf
    s_nop 1
    v_add_f32_dpp v32, v27, v32 quad_perm:[3,3,3,3] row_mask:0xf bank_mask:0xf
    s_xor_b32 s67, s20, 0x6000
    s_waitcnt vmcnt(13)
    buffer_load_dwordx4 v[108:111], v1, s[4:7], s67 offen offset:0 nt
    v_mfma_f32_16x16x32_bf16 v[24:27], v[116:119], v[4:7], 0
    v_mov_b32_dpp v33, v28 quad_perm:[0,0,0,0] row_mask:0xf bank_mask:0xf
    s_nop 1
    v_add_f32_dpp v33, v29, v33 quad_perm:[1,1,1,1] row_mask:0xf bank_mask:0xf
    s_nop 1
    v_add_f32_dpp v33, v30, v33 quad_perm:[2,2,2,2] row_mask:0xf bank_mask:0xf
    s_nop 1
    v_add_f32_dpp v33, v31, v33 quad_perm:[3,3,3,3] row_mask:0xf bank_mask:0xf
    s_waitcnt vmcnt(13)
    buffer_load_dwordx4 v[112:115], v1, s[4:7], s67 offen offset:2048 nt
    v_mfma_f32_16x16x32_bf16 v[28:31], v[120:123], v[4:7], 0
    v_mov_b32_dpp v34, v24 quad_perm:[0,0,0,0] row_mask:0xf bank_mask:0xf
    s_nop 1
    v_add_f32_dpp v34, v25, v34 quad_perm:[1,1,1,1] row_mask:0xf bank_mask:0xf
    s_nop 1
    v_add_f32_dpp v34, v26, v34 quad_perm:[2,2,2,2] row_mask:0xf bank_mask:0xf
    s_nop 1
    v_add_f32_dpp v34, v27, v34 quad_perm:[3,3,3,3] row_mask:0xf bank_mask:0xf
    s_waitcnt vmcnt(13)
    buffer_load_dwordx4 v[116:119], v1, s[4:7], s67 offen offset:256 nt
    v_mfma_f32_16x16x32_bf16 v[24:27], v[60:63], v[4:7], 0
    v_mov_b32_dpp v35, v28 quad_perm:[0,0,0,0] row_mask:0xf bank_mask:0xf
    s_nop 1
    v_add_f32_dpp v35, v29, v35 quad_perm:[1,1,1,1] row_mask:0xf bank_mask:0xf
    s_nop 1
    v_add_f32_dpp v35, v30, v35 quad_perm:[2,2,2,2] row_mask:0xf bank_mask:0xf
    s_nop 1
    v_add_f32_dpp v35, v31, v35 quad_perm:[3,3,3,3] row_mask:0xf bank_mask:0xf
    ds_write_b128 v3, v[32:35] offset:768
    v_max3_f32 v16, v16, v32, v33
    v_max3_f32 v16, v16, v34, v35
    v_add_u32 v3, 1024, v3
    s_waitcnt vmcnt(13)
    buffer_load_dwordx4 v[120:123], v1, s[4:7], s67 offen offset:2304 nt
    s_add_u32 s21, s21, 1
    s_ff1_i32_b32 m0, s21
    s_nop 0
    s_movrels_b32 s67, s72
    s_xor_b32 s20, s20, s67
    s_cmp_lg_u32 s21, s60
    s_cbranch_scc1 L_loop1_5
    s_branch L_ctl1
L_boost1:
    s_add_u32 s57, s61, s21
    s_min_u32 s60, s60, s57
    s_sub_u32 s61, s57, s60
    s_add_u32 s58, s58, s39
    s_branch L_pick1
L_other1:
    s_cmp_eq_u32 s58, 3
    s_cbranch_scc1 L_loop1_3
    s_cmp_eq_u32 s58, 0
    s_cbranch_scc1 L_loop1_0
    s_cmp_eq_u32 s58, 2
    s_cbranch_scc1 L_loop1_2
    s_cmp_eq_u32 s58, 4
    s_cbranch_scc1 L_loop1_4
    s_branch L_loop1_5
L_ctl1:
    s_cmp_eq_u32 s59, 0
    s_cbranch_scc1 L_nocons1
    s_mov_b32 s59, 0
    s_waitcnt lgkmcnt(0)
    s_min_u32 s57, s65, 31
    s_lshl_b32 s57, s57, 1
    s_sub_i32 s57, s57, 31
    s_mul_i32 s58, s57, s57
    s_mul_i32 s58, s58, 2253
    s_lshr_b32 s58, s58, 8
    s_add_u32 s58, s58, 6342
    s_mul_i32 s61, s58, s57
    s_add_i32 s61, s61, 0x8000
    s_ashr_i32 s61, s61, 16
    s_cmp_gt_i32 s61, 0
    s_cselect_b32 s39, 2, -1
    s_abs_i32 s61, s61
    s_add_u32 s33, s33, 1
    s_cmp_gt_i32 s57, 21
    s_cselect_b32 s33, s33, 0
    s_cmp_gt_u32 s33, 2
    s_addc_u32 s66, s66, 0
    s_cmp_lt_i32 s57, 0
    s_subb_u32 s66, s66, 0
    s_max_u32 s66, s66, 1
    s_min_u32 s66, s66, 5
L_nocons1:
    s_sub_u32 s57, s21, 2
    s_bitcmp1_b64 s[82:83], s57
    s_cbranch_scc0 L_norep1
    s_add_u32 s64, s64, s63
    s_and_b32 s57, s64, 15
    s_add_u32 s57, s57, s62
    s_lshl_b32 s57, s57, 8
    s_add_u32 s62, s62, 16
    s_mov_b32 s65, 1
    s_mov_b32 s59, 1
    s_atomic_add s65, s[68:69], s57 glc
L_norep1:
    s_cmp_lt_u32 s21, 64
    s_cbranch_scc1 L_plan1
    s_mov_b64 s[4:5], s[8:9]
    v_mov_b32 v1, v2
    s_cmp_lt_u32 s21, 65
    s_cbranch_scc1 L_plan1
L_exit1:
    ds_read_b32 v23, v22
    ds_read_b32 v39, v22 offset:256
    v_mov_b32 v21, v16
    s_nop 1
    v_permlane16_swap_b32 v16, v21
    s_nop 1
    v_max_f32 v16, v16, v21
    v_mov_b32 v21, v16
    s_nop 1
    v_permlane32_swap_b32 v16, v21
    s_nop 1
    v_max_f32 v16, v16, v21
    s_waitcnt lgkmcnt(1)
    v_sub_f32 v36, v23, v16
    v_mul_f32 v36, s22, v36
    v_exp_f32 v36, v36
    ds_read_b32 v23, v22 offset:512
    s_nop 0
    v_cvt_pk_bf16_f32 v37, v36, v36
    s_nop 1
    v_and_b32_dpp v40, v37, v19 quad_perm:[0,0,0,0] row_mask:0xf bank_mask:0xf
    v_and_b32_dpp v41, v37, v20 quad_perm:[0,0,0,0] row_mask:0xf bank_mask:0xf
    v_and_b32_dpp v42, v37, v19 quad_perm:[1,1,1,1] row_mask:0xf bank_mask:0xf
    v_and_b32_dpp v43, v37, v20 quad_perm:[1,1,1,1] row_mask:0xf bank_mask:0xf
    v_and_b32_dpp v44, v37, v19 quad_perm:[2,2,2,2] row_mask:0xf bank_mask:0xf
    v_and_b32_dpp v45, v37, v20 quad_perm:[2,2,2,2] row_mask:0xf bank_mask:0xf
    v_and_b32_dpp v46, v37, v19 quad_perm:[3,3,3,3] row_mask:0xf bank_mask:0xf
    v_and_b32_dpp v47, v37, v20 quad_perm:[3,3,3,3] row_mask:0xf bank_mask:0xf
    s_mov_b32 s80, 0x30030030
    s_mov_b32 s81, 0x46060300
    s_mov_b32 s82, 0x10010010
    s_mov_b32 s83, 0x2020100
L_plan2:
    s_sub_u32 s57, s21, 65
    s_lshr_b64 s[10:11], s[80:81], s57
    s_ff1_i32_b64 s57, s[10:11]
    s_add_u32 s60, s21, s57
    s_add_u32 s60, s60, 1
    s_mov_b32 s58, s66
    s_cmp_lg_u32 s61, 0
    s_cbranch_scc1 L_boost2
L_pick2:
    s_cmp_lg_u32 s58, 1
    s_cbranch_scc1 L_other2
L_loop2_1:
    v_mfma_f32_16x16x16_bf16 v[8:11], v[40:41], v[60:61], v[8:11]
    v_mfma_f32_16x16x16_bf16 v[12:15], v[40:41], v[62:63], v[12:15]
    v_add_f32 v18, v18, v36
    s_waitcnt lgkmcnt(1)
    v_sub_f32 v36, v39, v16
    v_mul_f32 v36, s22, v36
    v_exp_f32 v36, v36
    ds_read_b32 v39, v22 offset:768
    s_waitcnt vmcnt(9)
    buffer_load_dwordx4 v[60:63], v1, s[4:7], s20 offen offset:0 nt
    v_mfma_f32_16x16x16_bf16 v[8:11], v[42:43], v[64:65], v[8:11]
    v_mfma_f32_16x16x16_bf16 v[12:15], v[42:43], v[66:67], v[12:15]
    v_cvt_pk_bf16_f32 v37, v36, v36
    s_waitcnt vmcnt(9)
    buffer_load_dwordx4 v[64:67], v1, s[4:7], s20 offen offset:2048 nt
    v_mfma_f32_16x16x16_bf16 v[8:11], v[44:45], v[68:69], v[8:11]
    v_mfma_f32_16x16x16_bf16 v[12:15], v[44:45], v[70:71], v[12:15]
    v_and_b32_dpp v48, v37, v19 quad_perm:[0,0,0,0] row_mask:0xf bank_mask:0xf
    v_and_b32_dpp v49, v37, v20 quad_perm:[0,0,0,0] row_mask:0xf bank_mask:0xf
    v_and_b32_dpp v50, v37, v19 quad_perm:[1,1,1,1] row_mask:0xf bank_mask:0xf
    v_and_b32_dpp v51, v37, v20 quad_perm:[1,1,1,1] row_mask:0xf bank_mask:0xf
    s_waitcnt vmcnt(9)
    buffer_load_dwordx4 v[68:71], v1, s[4:7], s20 offen offset:256 nt
    v_mfma_f32_16x16x16_bf16 v[8:11], v[46:47], v[72:73], v[8:11]
    v_mfma_f32_16x16x16_bf16 v[12:15], v[46:47], v[74:75], v[12:15]
    v_and_b32_dpp v52, v37, v19 quad_perm:[2,2,2,2] row_mask:0xf bank_mask:0xf
    v_and_b32_dpp v53, v37, v20 quad_perm:[2,2,2,2] row_mask:0xf bank_mask:0xf
    v_and_b32_dpp v54, v37, v19 quad_perm:[3,3,3,3] row_mask:0xf bank_mask:0xf
    v_and_b32_dpp v55, v37, v20 quad_perm:[3,3,3,3] row_mask:0xf bank_mask:0xf
    s_waitcnt vmcnt(9)
    buffer_load_dwordx4 v[72:75], v1, s[4:7], s20 offen offset:2304 nt
    v_mfma_f32_16x16x16_bf16 v[8:11], v[48:49], v[76:77], v[8:11]
    v_mfma_f32_16x16x16_bf16 v[12:15], v[48:49], v[78:79], v[12:15]
    v_add_f32 v18, v18, v36
    s_waitcnt lgkmcnt(1)
    v_sub_f32 v36, v23, v16
    v_mul_f32 v36, s22, v36
    v_exp_f32 v36, v36
    ds_read_b32 v23, v22 offset:1024
    s_xor_b32 s67, s20, 0x4000
    s_waitcnt vmcnt(9)
    buffer_load_dwordx4 v[76:79], v1, s[4:7], s67 offen offset:0 nt
    v_mfma_f32_16x16x16_bf16 v[8:11], v[50:51], v[80:81], v[8:11]
    v_mfma_f32_16x16x16_bf16 v[12:15], v[50:51], v[82:83], v[12:15]
    v_cvt_pk_bf16_f32 v37, v36, v36
    s_waitcnt vmcnt(9)
    buffer_load_dwordx4 v[80:83], v1, s[4:7], s67 offen offset:2048 nt
    v_mfma_f32_16x16x16_bf16 v[8:11], v[52:53], v[84:85], v[8:11]
    v_mfma_f32_16x16x16_bf16 v[12:15], v[52:53], v[86:87], v[12:15]
    v_and_b32_dpp v40, v37, v19 quad_perm:[0,0,0,0] row_mask:0xf bank_mask:0xf
    v_and_b32_dpp v41, v37, v20 quad_perm:[0,0,0,0] row_mask:0xf bank_mask:0xf
    v_and_b32_dpp v42, v37, v19 quad_perm:[1,1,1,1] row_mask:0xf bank_mask:0xf
    v_and_b32_dpp v43, v37, v20 quad_perm:[1,1,1,1] row_mask:0xf bank_mask:0xf
    s_waitcnt vmcnt(9)
    buffer_load_dwordx4 v[84:87], v1, s[4:7], s67 offen offset:256 nt
    v_mfma_f32_16x16x16_bf16 v[8:11], v[54:55], v[88:89], v[8:11]
    v_mfma_f32_16x16x16_bf16 v[12:15], v[54:55], v[90:91], v[12:15]
    v_and_b32_dpp v44, v37, v19 quad_perm:[2,2,2,2] row_mask:0xf bank_mask:0xf
    v_and_b32_dpp v45, v37, v20 quad_perm:[2,2,2,2] row_mask:0xf bank_mask:0xf
    v_and_b32_dpp v46, v37, v19 quad_perm:[3,3,3,3] row_mask:0xf bank_mask:0xf
    v_and_b32_dpp v47, v37, v20 quad_perm:[3,3,3,3] row_mask:0xf bank_mask:0xf
    s_waitcnt vmcnt(9)
    buffer_load_dwordx4 v[88:91], v1, s[4:7], s67 offen offset:2304 nt
    v_mfma_f32_16x16x16_bf16 v[8:11], v[40:41], v[92:93], v[8:11]
    v_mfma_f32_16x16x16_bf16 v[12:15], v[40:41], v[94:95], v[12:15]
    v_add_f32 v18, v18, v36
    s_waitcnt lgkmcnt(1)
    v_sub_f32 v36, v39, v16
    v_mul_f32 v36, s22, v36
    v_exp_f32 v36, v36
    ds_read_b32 v39, v22 offset:1280
    s_xor_b32 s67, s20, 0x2000
    s_waitcnt vmcnt(9)
    buffer_load_dwordx4 v[92:95], v1, s[4:7], s67 offen offset:0 nt
    v_mfma_f32_16x16x16_bf16 v[8:11], v[42:43], v[96:97], v[8:11]
    v_mfma_f32_16x16x16_bf16 v[12:15], v[42:43], v[98:99], v[12:15]
    v_cvt_pk_bf16_f32 v37, v36, v36
    s_waitcnt vmcnt(9)
    buffer_load_dwordx4 v[96:99], v1, s[4:7], s67 offen offset:2048 nt
    v_mfma_f32_16x16x16_bf16 v[8:11], v[44:45], v[100:101], v[8:11]
    v_mfma_f32_16x16x16_bf16 v[12:15], v[44:45], v[102:103], v[12:15]
    v_and_b32_dpp v48, v37, v19 quad_perm:[0,0,0,0] row_mask:0xf bank_mask:0xf
    v_and_b32_dpp v49, v37, v20 quad_perm:[0,0,0,0] row_mask:0xf bank_mask:0xf
    v_and_b32_dpp v50, v37, v19 quad_perm:[1,1,1,1] row_mask:0xf bank_mask:0xf
    v_and_b32_dpp v51, v37, v20 quad_perm:[1,1,1,1] row_mask:0xf bank_mask:0xf
    s_waitcnt vmcnt(9)
    buffer_load_dwordx4 v[100:103], v1, s[4:7], s67 offen offset:256 nt
    v_mfma_f32_16x16x16_bf16 v[8:11], v[46:47], v[104:105], v[8:11]
    v_mfma_f32_16x16x16_bf16 v[12:15], v[46:47], v[106:107], v[12:15]
    v_and_b32_dpp v52, v37, v19 quad_perm:[2,2,2,2] row_mask:0xf bank_mask:0xf
    v_and_b32_dpp v53, v37, v20 quad_perm:[2,2,2,2] row_mask:0xf bank_mask:0xf
    v_and_b32_dpp v54, v37, v19 quad_perm:[3,3,3,3] row_mask:0xf bank_mask:0xf
    v_and_b32_dpp v55, v37, v20 quad_perm:[3,3,3,3] row_mask:0xf bank_mask:0xf
    s_waitcnt vmcnt(9)
    buffer_load_dwordx4 v[104:107], v1, s[4:7], s67 offen offset:2304 nt
    v_mfma_f32_16x16x16_bf16 v[8:11], v[48:49], v[108:109], v[8:11]
    v_mfma_f32_16x16x16_bf16 v[12:15], v[48:49], v[110:111], v[12:15]
    v_add_f32 v18, v18, v36
    s_waitcnt lgkmcnt(1)
    v_sub_f32 v36, v23, v16
    v_mul_f32 v36, s22, v36
    v_exp_f32 v36, v36
    ds_read_b32 v23, v22 offset:1536
    s_xor_b32 s67, s20, 0x6000
    s_waitcnt vmcnt(9)
    buffer_load_dwordx4 v[108:111], v1, s[4:7], s67 offen offset:0 nt
    v_mfma_f32_16x16x16_bf16 v[8:11], v[50:51], v[112:113], v[8:11]
    v_mfma_f32_16x16x16_bf16 v[12:15], v[50:51], v[114:115], v[12:15]
    v_cvt_pk_bf16_f32 v37, v36, v36
    s_waitcnt vmcnt(9)
    buffer_load_dwordx4 v[112:115], v1, s[4:7], s67 offen offset:2048 nt
    v_mfma_f32_16x16x16_bf16 v[8:11], v[52:53], v[116:117], v[8:11]
    v_mfma_f32_16x16x16_bf16 v[12:15], v[52:53], v[118:119], v[12:15]
    v_and_b32_dpp v40, v37, v19 quad_perm:[0,0,0,0] row_mask:0xf bank_mask:0xf
    v_and_b32_dpp v41, v37, v20 quad_perm:[0,0,0,0] row_mask:0xf bank_mask:0xf
    v_and_b32_dpp v42, v37, v19 quad_perm:[1,1,1,1] row_mask:0xf bank_mask:0xf
    v_and_b32_dpp v43, v37, v20 quad_perm:[1,1,1,1] row_mask:0xf bank_mask:0xf
    s_waitcnt vmcnt(9)
    buffer_load_dwordx4 v[116:119], v1, s[4:7], s67 offen offset:256 nt
    v_mfma_f32_16x16x16_bf16 v[8:11], v[54:55], v[120:121], v[8:11]
    v_mfma_f32_16x16x16_bf16 v[12:15], v[54:55], v[122:123], v[12:15]
    v_and_b32_dpp v44, v37, v19 quad_perm:[2,2,2,2] row_mask:0xf bank_mask:0xf
    v_and_b32_dpp v45, v37, v20 quad_perm:[2,2,2,2] row_mask:0xf bank_mask:0xf
    v_and_b32_dpp v46, v37, v19 quad_perm:[3,3,3,3] row_mask:0xf bank_mask:0xf
    v_and_b32_dpp v47, v37, v20 quad_perm:[3,3,3,3] row_mask:0xf bank_mask:0xf
    v_add_u32 v22, 1024, v22
    s_waitcnt vmcnt(9)
    buffer_load_dwordx4 v[120:123], v1, s[4:7], s67 offen offset:2304 nt
    s_add_u32 s21, s21, 1
    s_ff1_i32_b32 m0, s21
    s_nop 0
    s_movrels_b32 s67, s72
    s_xor_b32 s20, s20, s67
    s_cmp_lg_u32 s21, s60
    s_cbranch_scc1 L_loop2_1
    s_branch L_ctl2
L_loop2_3:
    v_mfma_f32_16x16x16_bf16 v[8:11], v[40:41], v[60:61], v[8:11]
    v_mfma_f32_16x16x16_bf16 v[12:15], v[40:41], v[62:63], v[12:15]
    v_add_f32 v18, v18, v36
    s_waitcnt lgkmcnt(1)
    v_sub_f32 v36, v39, v16
    v_mul_f32 v36, s22, v36
    v_exp_f32 v36, v36
    ds_read_b32 v39, v22 offset:768
    s_waitcnt vmcnt(11)
    buffer_load_dwordx4 v[60:63], v1, s[4:7], s20 offen offset:0 nt
    v_mfma_f32_16x16x16_bf16 v[8:11], v[42:43], v[64:65], v[8:11]
    v_mfma_f32_16x16x16_bf16 v[12:15], v[42:43], v[66:67], v[12:15]
    v_cvt_pk_bf16_f32 v37, v36, v36
    s_waitcnt vmcnt(11)
    buffer_load_dwordx4 v[64:67], v1, s[4:7], s20 offen offset:2048 nt
    v_mfma_f32_16x16x16_bf16 v[8:11], v[44:45], v[68:69], v[8:11]
    v_mfma_f32_16x16x16_bf16 v[12:15], v[44:45], v[70:71], v[12:15]
    v_and_b32_dpp v48, v37, v19 quad_perm:[0,0,0,0] row_mask:0xf bank_mask:0xf
    v_and_b32_dpp v49, v37, v20 quad_perm:[0,0,0,0] row_mask:0xf bank_mask:0xf
    v_and_b32_dpp v50, v37, v19 quad_perm:[1,1,1,1] row_mask:0xf bank_mask:0xf
    v_and_b32_dpp v51, v37, v20 quad_perm:[1,1,1,1] row_mask:0xf bank_mask:0xf
    s_waitcnt vmcnt(11)
    buffer_load_dwordx4 v[68:71], v1, s[4:7], s20 offen offset:256 nt
    v_mfma_f32_16x16x16_bf16 v[8:11], v[46:47], v[72:73], v[8:11]
    v_mfma_f32_16x16x16_bf16 v[12:15], v[46:47], v[74:75], v[12:15]
    v_and_b32_dpp v52, v37, v19 quad_perm:[2,2,2,2] row_mask:0xf bank_mask:0xf
    v_and_b32_dpp v53, v37, v20 quad_perm:[2,2,2,2] row_mask:0xf bank_mask:0xf
    v_and_b32_dpp v54, v37, v19 quad_perm:[3,3,3,3] row_mask:0xf bank_mask:0xf
    v_and_b32_dpp v55, v37, v20 quad_perm:[3,3,3,3] row_mask:0xf bank_mask:0xf
    s_waitcnt vmcnt(11)
    buffer_load_dwordx4 v[72:75], v1, s[4:7], s20 offen offset:2304 nt
    v_mfma_f32_16x16x16_bf16 v[8:11], v[48:49], v[76:77], v[8:11]
    v_mfma_f32_16x16x16_bf16 v[12:15], v[48:49], v[78:79], v[12:15]
    v_add_f32 v18, v18, v36
    s_waitcnt lgkmcnt(1)
    v_sub_f32 v36, v23, v16
    v_mul_f32 v36, s22, v36
    v_exp_f32 v36, v36
    ds_read_b32 v23, v22 offset:1024
    s_xor_b32 s67, s20, 0x4000
    s_waitcnt vmcnt(11)
    buffer_load_dwordx4 v[76:79], v1, s[4:7], s67 offen offset:0 nt
    v_mfma_f32_16x16x16_bf16 v[8:11], v[50:51], v[80:81], v[8:11]
    v_mfma_f32_16x16x16_bf16 v[12:15], v[50:51], v[82:83], v[12:15]
    v_cvt_pk_bf16_f32 v37, v36, v36
    s_waitcnt vmcnt(11)
    buffer_load_dwordx4 v[80:83], v1, s[4:7], s67 offen offset:2048 nt
    v_mfma_f32_16x16x16_bf16 v[8:11], v[52:53], v[84:85], v[8:11]
    v_mfma_f32_16x16x16_bf16 v[12:15], v[52:53], v[86:87], v[12:15]
    v_and_b32_dpp v40, v37, v19 quad_perm:[0,0,0,0] row_mask:0xf bank_mask:0xf
    v_and_b32_dpp v41, v37, v20 quad_perm:[0,0,0,0] row_mask:0xf bank_mask:0xf
    v_and_b32_dpp v42, v37, v19 quad_perm:[1,1,1,1] row_mask:0xf bank_mask:0xf
    v_and_b32_dpp v43, v37, v20 quad_perm:[1,1,1,1] row_mask:0xf bank_mask:0xf
    s_waitcnt vmcnt(11)
    buffer_load_dwordx4 v[84:87], v1, s[4:7], s67 offen offset:256 nt
    v_mfma_f32_16x16x16_bf16 v[8:11], v[54:55], v[88:89], v[8:11]
    v_mfma_f32_16x16x16_bf16 v[12:15], v[54:55], v[90:91], v[12:15]
    v_and_b32_dpp v44, v37, v19 quad_perm:[2,2,2,2] row_mask:0xf bank_mask:0xf
    v_and_b32_dpp v45, v37, v20 quad_perm:[2,2,2,2] row_mask:0xf bank_mask:0xf
    v_and_b32_dpp v46, v37, v19 quad_perm:[3,3,3,3] row_mask:0xf bank_mask:0xf
    v_and_b32_dpp v47, v37, v20 quad_perm:[3,3,3,3] row_mask:0xf bank_mask:0xf
    s_waitcnt vmcnt(11)
    buffer_load_dwordx4 v[88:91], v1, s[4:7], s67 offen offset:2304 nt
    v_mfma_f32_16x16x16_bf16 v[8:11], v[40:41], v[92:93], v[8:11]
    v_mfma_f32_16x16x16_bf16 v[12:15], v[40:41], v[94:95], v[12:15]
    v_add_f32 v18, v18, v36
    s_waitcnt lgkmcnt(1)
    v_sub_f32 v36, v39, v16
    v_mul_f32 v36, s22, v36
    v_exp_f32 v36, v36
    ds_read_b32 v39, v22 offset:1280
    s_xor_b32 s67, s20, 0x2000
    s_waitcnt vmcnt(11)
    buffer_load_dwordx4 v[92:95], v1, s[4:7], s67 offen offset:0 nt
    v_mfma_f32_16x16x16_bf16 v[8:11], v[42:43], v[96:97], v[8:11]
    v_mfma_f32_16x16x16_bf16 v[12:15], v[42:43], v[98:99], v[12:15]
    v_cvt_pk_bf16_f32 v37, v36, v36
    s_waitcnt vmcnt(11)
    buffer_load_dwordx4 v[96:99], v1, s[4:7], s67 offen offset:2048 nt
    v_mfma_f32_16x16x16_bf16 v[8:11], v[44:45], v[100:101], v[8:11]
    v_mfma_f32_16x16x16_bf16 v[12:15], v[44:45], v[102:103], v[12:15]
    v_and_b32_dpp v48, v37, v19 quad_perm:[0,0,0,0] row_mask:0xf bank_mask:0xf
    v_and_b32_dpp v49, v37, v20 quad_perm:[0,0,0,0] row_mask:0xf bank_mask:0xf
    v_and_b32_dpp v50, v37, v19 quad_perm:[1,1,1,1] row_mask:0xf bank_mask:0xf
    v_and_b32_dpp v51, v37, v20 quad_perm:[1,1,1,1] row_mask:0xf bank_mask:0xf
    s_waitcnt vmcnt(11)
    buffer_load_dwordx4 v[100:103], v1, s[4:7], s67 offen offset:256 nt
    v_mfma_f32_16x16x16_bf16 v[8:11], v[46:47], v[104:105], v[8:11]
    v_mfma_f32_16x16x16_bf16 v[12:15], v[46:47], v[106:107], v[12:15]
    v_and_b32_dpp v52, v37, v19 quad_perm:[2,2,2,2] row_mask:0xf bank_mask:0xf
    v_and_b32_dpp v53, v37, v20 quad_perm:[2,2,2,2] row_mask:0xf bank_mask:0xf
    v_and_b32_dpp v54, v37, v19 quad_perm:[3,3,3,3] row_mask:0xf bank_mask:0xf
    v_and_b32_dpp v55, v37, v20 quad_perm:[3,3,3,3] row_mask:0xf bank_mask:0xf
    s_waitcnt vmcnt(11)
    buffer_load_dwordx4 v[104:107], v1, s[4:7], s67 offen offset:2304 nt
    v_mfma_f32_16x16x16_bf16 v[8:11], v[48:49], v[108:109], v[8:11]
    v_mfma_f32_16x16x16_bf16 v[12:15], v[48:49], v[110:111], v[12:15]
    v_add_f32 v18, v18, v36
    s_waitcnt lgkmcnt(1)
    v_sub_f32 v36, v23, v16
    v_mul_f32 v36, s22, v36
    v_exp_f32 v36, v36
    ds_read_b32 v23, v22 offset:1536
    s_xor_b32 s67, s20, 0x6000
    s_waitcnt vmcnt(11)
    buffer_load_dwordx4 v[108:111], v1, s[4:7], s67 offen offset:0 nt
    v_mfma_f32_16x16x16_bf16 v[8:11], v[50:51], v[112:113], v[8:11]
    v_mfma_f32_16x16x16_bf16 v[12:15], v[50:51], v[114:115], v[12:15]
    v_cvt_pk_bf16_f32 v37, v36, v36
    s_waitcnt vmcnt(11)
    buffer_load_dwordx4 v[112:115], v1, s[4:7], s67 offen offset:2048 nt
    v_mfma_f32_16x16x16_bf16 v[8:11], v[52:53], v[116:117], v[8:11]
    v_mfma_f32_16x16x16_bf16 v[12:15], v[52:53], v[118:119], v[12:15]
    v_and_b32_dpp v40, v37, v19 quad_perm:[0,0,0,0] row_mask:0xf bank_mask:0xf
    v_and_b32_dpp v41, v37, v20 quad_perm:[0,0,0,0] row_mask:0xf bank_mask:0xf
    v_and_b32_dpp v42, v37, v19 quad_perm:[1,1,1,1] row_mask:0xf bank_mask:0xf
    v_and_b32_dpp v43, v37, v20 quad_perm:[1,1,1,1] row_mask:0xf bank_mask:0xf
    s_waitcnt vmcnt(11)
    buffer_load_dwordx4 v[116:119], v1, s[4:7], s67 offen offset:256 nt
    v_mfma_f32_16x16x16_bf16 v[8:11], v[54:55], v[120:121], v[8:11]
    v_mfma_f32_16x16x16_bf16 v[12:15], v[54:55], v[122:123], v[12:15]
    v_and_b32_dpp v44, v37, v19 quad_perm:[2,2,2,2] row_mask:0xf bank_mask:0xf
    v_and_b32_dpp v45, v37, v20 quad_perm:[2,2,2,2] row_mask:0xf bank_mask:0xf
    v_and_b32_dpp v46, v37, v19 quad_perm:[3,3,3,3] row_mask:0xf bank_mask:0xf
    v_and_b32_dpp v47, v37, v20 quad_perm:[3,3,3,3] row_mask:0xf bank_mask:0xf
    v_add_u32 v22, 1024, v22
    s_waitcnt vmcnt(11)
    buffer_load_dwordx4 v[120:123], v1, s[4:7], s67 offen offset:2304 nt
    s_add_u32 s21, s21, 1
    s_ff1_i32_b32 m0, s21
    s_nop 0
    s_movrels_b32 s67, s72
    s_xor_b32 s20, s20, s67
    s_cmp_lg_u32 s21, s60
    s_cbranch_scc1 L_loop2_3
    s_branch L_ctl2
L_loop2_0:
    v_mfma_f32_16x16x16_bf16 v[8:11], v[40:41], v[60:61], v[8:11]
    v_mfma_f32_16x16x16_bf16 v[12:15], v[40:41], v[62:63], v[12:15]
    v_add_f32 v18, v18, v36
    s_waitcnt lgkmcnt(1)
    v_sub_f32 v36, v39, v16
    v_mul_f32 v36, s22, v36
    v_exp_f32 v36, v36
    ds_read_b32 v39, v22 offset:768
    s_waitcnt vmcnt(8)
    buffer_load_dwordx4 v[60:63], v1, s[4:7], s20 offen offset:0 nt
    v_mfma_f32_16x16x16_bf16 v[8:11], v[42:43], v[64:65], v[8:11]
    v_mfma_f32_16x16x16_bf16 v[12:15], v[42:43], v[66:67], v[12:15]
    v_cvt_pk_bf16_f32 v37, v36, v36
    s_waitcnt vmcnt(8)
    buffer_load_dwordx4 v[64:67], v1, s[4:7], s20 offen offset:2048 nt
    v_mfma_f32_16x16x16_bf16 v[8:11], v[44:45], v[68:69], v[8:11]
    v_mfma_f32_16x16x16_bf16 v[12:15], v[44:45], v[70:71], v[12:15]
    v_and_b32_dpp v48, v37, v19 quad_perm:[0,0,0,0] row_mask:0xf bank_mask:0xf
    v_and_b32_dpp v49, v37, v20 quad_perm:[0,0,0,0] row_mask:0xf bank_mask:0xf
    v_and_b32_dpp v50, v37, v19 quad_perm:[1,1,1,1] row_mask:0xf bank_mask:0xf
    v_and_b32_dpp v51, v37, v20 quad_perm:[1,1,1,1] row_mask:0xf bank_mask:0xf
    s_waitcnt vmcnt(8)
    buffer_load_dwordx4 v[68:71], v1, s[4:7], s20 offen offset:256 nt
    v_mfma_f32_16x16x16_bf16 v[8:11], v[46:47], v[72:73], v[8:11]
    v_mfma_f32_16x16x16_bf16 v[12:15], v[46:47], v[74:75], v[12:15]
    v_and_b32_dpp v52, v37, v19 quad_perm:[2,2,2,2] row_mask:0xf bank_mask:0xf
    v_and_b32_dpp v53, v37, v20 quad_perm:[2,2,2,2] row_mask:0xf bank_mask:0xf
    v_and_b32_dpp v54, v37, v19 quad_perm:[3,3,3,3] row_mask:0xf bank_mask:0xf
    v_and_b32_dpp v55, v37, v20 quad_perm:[3,3,3,3] row_mask:0xf bank_mask:0xf
    s_waitcnt vmcnt(8)
    buffer_load_dwordx4 v[72:75], v1, s[4:7], s20 offen offset:2304 nt
    v_mfma_f32_16x16x16_bf16 v[8:11], v[48:49], v[76:77], v[8:11]
    v_mfma_f32_16x16x16_bf16 v[12:15], v[48:49], v[78:79], v[12:15]
    v_add_f32 v18, v18, v36
    s_waitcnt lgkmcnt(1)
    v_sub_f32 v36, v23, v16
    v_mul_f32 v36, s22, v36
    v_exp_f32 v36, v36
    ds_read_b32 v23, v22 offset:1024
    s_xor_b32 s67, s20, 0x4000
    s_waitcnt vmcnt(8)
    buffer_load_dwordx4 v[76:79], v1, s[4:7], s67 offen offset:0 nt
    v_mfma_f32_16x16x16_bf16 v[8:11], v[50:51], v[80:81], v[8:11]
    v_mfma_f32_16x16x16_bf16 v[12:15], v[50:51], v[82:83], v[12:15]
    v_cvt_pk_bf16_f32 v37, v36, v36
    s_waitcnt vmcnt(8)
    buffer_load_dwordx4 v[80:83], v1, s[4:7], s67 offen offset:2048 nt
    v_mfma_f32_16x16x16_bf16 v[8:11], v[52:53], v[84:85], v[8:11]
    v_mfma_f32_16x16x16_bf16 v[12:15], v[52:53], v[86:87], v[12:15]
    v_and_b32_dpp v40, v37, v19 quad_perm:[0,0,0,0] row_mask:0xf bank_mask:0xf
    v_and_b32_dpp v41, v37, v20 quad_perm:[0,0,0,0] row_mask:0xf bank_mask:0xf
    v_and_b32_dpp v42, v37, v19 quad_perm:[1,1,1,1] row_mask:0xf bank_mask:0xf
    v_and_b32_dpp v43, v37, v20 quad_perm:[1,1,1,1] row_mask:0xf bank_mask:0xf
    s_waitcnt vmcnt(8)
    buffer_load_dwordx4 v[84:87], v1, s[4:7], s67 offen offset:256 nt
    v_mfma_f32_16x16x16_bf16 v[8:11], v[54:55], v[88:89], v[8:11]
    v_mfma_f32_16x16x16_bf16 v[12:15], v[54:55], v[90:91], v[12:15]
    v_and_b32_dpp v44, v37, v19 quad_perm:[2,2,2,2] row_mask:0xf bank_mask:0xf
    v_and_b32_dpp v45, v37, v20 quad_perm:[2,2,2,2] row_mask:0xf bank_mask:0xf
    v_and_b32_dpp v46, v37, v19 quad_perm:[3,3,3,3] row_mask:0xf bank_mask:0xf
    v_and_b32_dpp v47, v37, v20 quad_perm:[3,3,3,3] row_mask:0xf bank_mask:0xf
    s_waitcnt vmcnt(8)
    buffer_load_dwordx4 v[88:91], v1, s[4:7], s67 offen offset:2304 nt
    v_mfma_f32_16x16x16_bf16 v[8:11], v[40:41], v[92:93], v[8:11]
    v_mfma_f32_16x16x16_bf16 v[12:15], v[40:41], v[94:95], v[12:15]
    v_add_f32 v18, v18, v36
    s_waitcnt lgkmcnt(1)
    v_sub_f32 v36, v39, v16
    v_mul_f32 v36, s22, v36
    v_exp_f32 v36, v36
    ds_read_b32 v39, v22 offset:1280
    s_xor_b32 s67, s20, 0x2000
    s_waitcnt vmcnt(8)
    buffer_load_dwordx4 v[92:95], v1, s[4:7], s67 offen offset:0 nt
    v_mfma_f32_16x16x16_bf16 v[8:11], v[42:43], v[96:97], v[8:11]
    v_mfma_f32_16x16x16_bf16 v[12:15], v[42:43], v[98:99], v[12:15]
    v_cvt_pk_bf16_f32 v37, v36, v36
    s_waitcnt vmcnt(8)
    buffer_load_dwordx4 v[96:99], v1, s[4:7], s67 offen offset:2048 nt
    v_mfma_f32_16x16x16_bf16 v[8:11], v[44:45], v[100:101], v[8:11]
    v_mfma_f32_16x16x16_bf16 v[12:15], v[44:45], v[102:103], v[12:15]
    v_and_b32_dpp v48, v37, v19 quad_perm:[0,0,0,0] row_mask:0xf bank_mask:0xf
    v_and_b32_dpp v49, v37, v20 quad_perm:[0,0,0,0] row_mask:0xf bank_mask:0xf
    v_and_b32_dpp v50, v37, v19 quad_perm:[1,1,1,1] row_mask:0xf bank_mask:0xf
    v_and_b32_dpp v51, v37, v20 quad_perm:[1,1,1,1] row_mask:0xf bank_mask:0xf
    s_waitcnt vmcnt(8)
    buffer_load_dwordx4 v[100:103], v1, s[4:7], s67 offen offset:256 nt
    v_mfma_f32_16x16x16_bf16 v[8:11], v[46:47], v[104:105], v[8:11]
    v_mfma_f32_16x16x16_bf16 v[12:15], v[46:47], v[106:107], v[12:15]
    v_and_b32_dpp v52, v37, v19 quad_perm:[2,2,2,2] row_mask:0xf bank_mask:0xf
    v_and_b32_dpp v53, v37, v20 quad_perm:[2,2,2,2] row_mask:0xf bank_mask:0xf
    v_and_b32_dpp v54, v37, v19 quad_perm:[3,3,3,3] row_mask:0xf bank_mask:0xf
    v_and_b32_dpp v55, v37, v20 quad_perm:[3,3,3,3] row_mask:0xf bank_mask:0xf
    s_waitcnt vmcnt(8)
    buffer_load_dwordx4 v[104:107], v1, s[4:7], s67 offen offset:2304 nt
    v_mfma_f32_16x16x16_bf16 v[8:11], v[48:49], v[108:109], v[8:11]
    v_mfma_f32_16x16x16_bf16 v[12:15], v[48:49], v[110:111], v[12:15]
    v_add_f32 v18, v18, v36
    s_waitcnt lgkmcnt(1)
    v_sub_f32 v36, v23, v16
    v_mul_f32 v36, s22, v36
    v_exp_f32 v36, v36
    ds_read_b32 v23, v22 offset:1536
    s_xor_b32 s67, s20, 0x6000
    s_waitcnt vmcnt(8)
    buffer_load_dwordx4 v[108:111], v1, s[4:7], s67 offen offset:0 nt
    v_mfma_f32_16x16x16_bf16 v[8:11], v[50:51], v[112:113], v[8:11]
    v_mfma_f32_16x16x16_bf16 v[12:15], v[50:51], v[114:115], v[12:15]
    v_cvt_pk_bf16_f32 v37, v36, v36
    s_waitcnt vmcnt(8)
    buffer_load_dwordx4 v[112:115], v1, s[4:7], s67 offen offset:2048 nt
    v_mfma_f32_16x16x16_bf16 v[8:11], v[52:53], v[116:117], v[8:11]
    v_mfma_f32_16x16x16_bf16 v[12:15], v[52:53], v[118:119], v[12:15]
    v_and_b32_dpp v40, v37, v19 quad_perm:[0,0,0,0] row_mask:0xf bank_mask:0xf
    v_and_b32_dpp v41, v37, v20 quad_perm:[0,0,0,0] row_mask:0xf bank_mask:0xf
    v_and_b32_dpp v42, v37, v19 quad_perm:[1,1,1,1] row_mask:0xf bank_mask:0xf
    v_and_b32_dpp v43, v37, v20 quad_perm:[1,1,1,1] row_mask:0xf bank_mask:0xf
    s_waitcnt vmcnt(8)
    buffer_load_dwordx4 v[116:119], v1, s[4:7], s67 offen offset:256 nt
    v_mfma_f32_16x16x16_bf16 v[8:11], v[54:55], v[120:121], v[8:11]
    v_mfma_f32_16x16x16_bf16 v[12:15], v[54:55], v[122:123], v[12:15]
    v_and_b32_dpp v44, v37, v19 quad_perm:[2,2,2,2] row_mask:0xf bank_mask:0xf
    v_and_b32_dpp v45, v37, v20 quad_perm:[2,2,2,2] row_mask:0xf bank_mask:0xf
    v_and_b32_dpp v46, v37, v19 quad_perm:[3,3,3,3] row_mask:0xf bank_mask:0xf
    v_and_b32_dpp v47, v37, v20 quad_perm:[3,3,3,3] row_mask:0xf bank_mask:0xf
    v_add_u32 v22, 1024, v22
    s_waitcnt vmcnt(8)
    buffer_load_dwordx4 v[120:123], v1, s[4:7], s67 offen offset:2304 nt
    s_add_u32 s21, s21, 1
    s_ff1_i32_b32 m0, s21
    s_nop 0
    s_movrels_b32 s67, s72
    s_xor_b32 s20, s20, s67
    s_cmp_lg_u32 s21, s60
    s_cbranch_scc1 L_loop2_0
    s_branch L_ctl2
L_loop2_2:
    v_mfma_f32_16x16x16_bf16 v[8:11], v[40:41], v[60:61], v[8:11]
    v_mfma_f32_16x16x16_bf16 v[12:15], v[40:41], v[62:63], v[12:15]
    v_add_f32 v18, v18, v36
    s_waitcnt lgkmcnt(1)
    v_sub_f32 v36, v39, v16
    v_mul_f32 v36, s22, v36
    v_exp_f32 v36, v36
    ds_read_b32 v39, v22 offset:768
    s_waitcnt vmcnt(10)
    buffer_load_dwordx4 v[60:63], v1, s[4:7], s20 offen offset:0 nt
    v_mfma_f32_16x16x16_bf16 v[8:11], v[42:43], v[64:65], v[8:11]
    v_mfma_f32_16x16x16_bf16 v[12:15], v[42:43], v[66:67], v[12:15]
    v_cvt_pk_bf16_f32 v37, v36, v36
    s_waitcnt vmcnt(10)
    buffer_load_dwordx4 v[64:67], v1, s[4:7], s20 offen offset:2048 nt
    v_mfma_f32_16x16x16_bf16 v[8:11], v[44:45], v[68:69], v[8:11]
    v_mfma_f32_16x16x16_bf16 v[12:15], v[44:45], v[70:71], v[12:15]
    v_and_b32_dpp v48, v37, v19 quad_perm:[0,0,0,0] row_mask:0xf bank_mask:0xf
    v_and_b32_dpp v49, v37, v20 quad_perm:[0,0,0,0] row_mask:0xf bank_mask:0xf
    v_and_b32_dpp v50, v37, v19 quad_perm:[1,1,1,1] row_mask:0xf bank_mask:0xf
    v_and_b32_dpp v51, v37, v20 quad_perm:[1,1,1,1] row_mask:0xf bank_mask:0xf
    s_waitcnt vmcnt(10)
    buffer_load_dwordx4 v[68:71], v1, s[4:7], s20 offen offset:256 nt
    v_mfma_f32_16x16x16_bf16 v[8:11], v[46:47], v[72:73], v[8:11]
    v_mfma_f32_16x16x16_bf16 v[12:15], v[46:47], v[74:75], v[12:15]
    v_and_b32_dpp v52, v37, v19 quad_perm:[2,2,2,2] row_mask:0xf bank_mask:0xf
    v_and_b32_dpp v53, v37, v20 quad_perm:[2,2,2,2] row_mask:0xf bank_mask:0xf
    v_and_b32_dpp v54, v37, v19 quad_perm:[3,3,3,3] row_mask:0xf bank_mask:0xf
    v_and_b32_dpp v55, v37, v20 quad_perm:[3,3,3,3] row_mask:0xf bank_mask:0xf
    s_waitcnt vmcnt(10)
    buffer_load_dwordx4 v[72:75], v1, s[4:7], s20 offen offset:2304 nt
    v_mfma_f32_16x16x16_bf16 v[8:11], v[48:49], v[76:77], v[8:11]
    v_mfma_f32_16x16x16_bf16 v[12:15], v[48:49], v[78:79], v[12:15]
    v_add_f32 v18, v18, v36
    s_waitcnt lgkmcnt(1)
    v_sub_f32 v36, v23, v16
    v_mul_f32 v36, s22, v36
    v_exp_f32 v36, v36
    ds_read_b32 v23, v22 offset:1024
    s_xor_b32 s67, s20, 0x4000
    s_waitcnt vmcnt(10)
    buffer_load_dwordx4 v[76:79], v1, s[4:7], s67 offen offset:0 nt
    v_mfma_f32_16x16x16_bf16 v[8:11], v[50:51], v[80:81], v[8:11]
    v_mfma_f32_16x16x16_bf16 v[12:15], v[50:51], v[82:83], v[12:15]
    v_cvt_pk_bf16_f32 v37, v36, v36
    s_waitcnt vmcnt(10)
    buffer_load_dwordx4 v[80:83], v1, s[4:7], s67 offen offset:2048 nt
    v_mfma_f32_16x16x16_bf16 v[8:11], v[52:53], v[84:85], v[8:11]
    v_mfma_f32_16x16x16_bf16 v[12:15], v[52:53], v[86:87], v[12:15]
    v_and_b32_dpp v40, v37, v19 quad_perm:[0,0,0,0] row_mask:0xf bank_mask:0xf
    v_and_b32_dpp v41, v37, v20 quad_perm:[0,0,0,0] row_mask:0xf bank_mask:0xf
    v_and_b32_dpp v42, v37, v19 quad_perm:[1,1,1,1] row_mask:0xf bank_mask:0xf
    v_and_b32_dpp v43, v37, v20 quad_perm:[1,1,1,1] row_mask:0xf bank_mask:0xf
    s_waitcnt vmcnt(10)
    buffer_load_dwordx4 v[84:87], v1, s[4:7], s67 offen offset:256 nt
    v_mfma_f32_16x16x16_bf16 v[8:11], v[54:55], v[88:89], v[8:11]
    v_mfma_f32_16x16x16_bf16 v[12:15], v[54:55], v[90:91], v[12:15]
    v_and_b32_dpp v44, v37, v19 quad_perm:[2,2,2,2] row_mask:0xf bank_mask:0xf
    v_and_b32_dpp v45, v37, v20 quad_perm:[2,2,2,2] row_mask:0xf bank_mask:0xf
    v_and_b32_dpp v46, v37, v19 quad_perm:[3,3,3,3] row_mask:0xf bank_mask:0xf
    v_and_b32_dpp v47, v37, v20 quad_perm:[3,3,3,3] row_mask:0xf bank_mask:0xf
    s_waitcnt vmcnt(10)
    buffer_load_dwordx4 v[88:91], v1, s[4:7], s67 offen offset:2304 nt
    v_mfma_f32_16x16x16_bf16 v[8:11], v[40:41], v[92:93], v[8:11]
    v_mfma_f32_16x16x16_bf16 v[12:15], v[40:41], v[94:95], v[12:15]
    v_add_f32 v18, v18, v36
    s_waitcnt lgkmcnt(1)
    v_sub_f32 v36, v39, v16
    v_mul_f32 v36, s22, v36
    v_exp_f32 v36, v36
    ds_read_b32 v39, v22 offset:1280
    s_xor_b32 s67, s20, 0x2000
    s_waitcnt vmcnt(10)
    buffer_load_dwordx4 v[92:95], v1, s[4:7], s67 offen offset:0 nt
    v_mfma_f32_16x16x16_bf16 v[8:11], v[42:43], v[96:97], v[8:11]
    v_mfma_f32_16x16x16_bf16 v[12:15], v[42:43], v[98:99], v[12:15]
    v_cvt_pk_bf16_f32 v37, v36, v36
    s_waitcnt vmcnt(10)
    buffer_load_dwordx4 v[96:99], v1, s[4:7], s67 offen offset:2048 nt
    v_mfma_f32_16x16x16_bf16 v[8:11], v[44:45], v[100:101], v[8:11]
    v_mfma_f32_16x16x16_bf16 v[12:15], v[44:45], v[102:103], v[12:15]
    v_and_b32_dpp v48, v37, v19 quad_perm:[0,0,0,0] row_mask:0xf bank_mask:0xf
    v_and_b32_dpp v49, v37, v20 quad_perm:[0,0,0,0] row_mask:0xf bank_mask:0xf
    v_and_b32_dpp v50, v37, v19 quad_perm:[1,1,1,1] row_mask:0xf bank_mask:0xf
    v_and_b32_dpp v51, v37, v20 quad_perm:[1,1,1,1] row_mask:0xf bank_mask:0xf
    s_waitcnt vmcnt(10)
    buffer_load_dwordx4 v[100:103], v1, s[4:7], s67 offen offset:256 nt
    v_mfma_f32_16x16x16_bf16 v[8:11], v[46:47], v[104:105], v[8:11]
    v_mfma_f32_16x16x16_bf16 v[12:15], v[46:47], v[106:107], v[12:15]
    v_and_b32_dpp v52, v37, v19 quad_perm:[2,2,2,2] row_mask:0xf bank_mask:0xf
    v_and_b32_dpp v53, v37, v20 quad_perm:[2,2,2,2] row_mask:0xf bank_mask:0xf
    v_and_b32_dpp v54, v37, v19 quad_perm:[3,3,3,3] row_mask:0xf bank_mask:0xf
    v_and_b32_dpp v55, v37, v20 quad_perm:[3,3,3,3] row_mask:0xf bank_mask:0xf
    s_waitcnt vmcnt(10)
    buffer_load_dwordx4 v[104:107], v1, s[4:7], s67 offen offset:2304 nt
    v_mfma_f32_16x16x16_bf16 v[8:11], v[48:49], v[108:109], v[8:11]
    v_mfma_f32_16x16x16_bf16 v[12:15], v[48:49], v[110:111], v[12:15]
    v_add_f32 v18, v18, v36
    s_waitcnt lgkmcnt(1)
    v_sub_f32 v36, v23, v16
    v_mul_f32 v36, s22, v36
    v_exp_f32 v36, v36
    ds_read_b32 v23, v22 offset:1536
    s_xor_b32 s67, s20, 0x6000
    s_waitcnt vmcnt(10)
    buffer_load_dwordx4 v[108:111], v1, s[4:7], s67 offen offset:0 nt
    v_mfma_f32_16x16x16_bf16 v[8:11], v[50:51], v[112:113], v[8:11]
    v_mfma_f32_16x16x16_bf16 v[12:15], v[50:51], v[114:115], v[12:15]
    v_cvt_pk_bf16_f32 v37, v36, v36
    s_waitcnt vmcnt(10)
    buffer_load_dwordx4 v[112:115], v1, s[4:7], s67 offen offset:2048 nt
    v_mfma_f32_16x16x16_bf16 v[8:11], v[52:53], v[116:117], v[8:11]
    v_mfma_f32_16x16x16_bf16 v[12:15], v[52:53], v[118:119], v[12:15]
    v_and_b32_dpp v40, v37, v19 quad_perm:[0,0,0,0] row_mask:0xf bank_mask:0xf
    v_and_b32_dpp v41, v37, v20 quad_perm:[0,0,0,0] row_mask:0xf bank_mask:0xf
    v_and_b32_dpp v42, v37, v19 quad_perm:[1,1,1,1] row_mask:0xf bank_mask:0xf
    v_and_b32_dpp v43, v37, v20 quad_perm:[1,1,1,1] row_mask:0xf bank_mask:0xf
    s_waitcnt vmcnt(10)
    buffer_load_dwordx4 v[116:119], v1, s[4:7], s67 offen offset:256 nt
    v_mfma_f32_16x16x16_bf16 v[8:11], v[54:55], v[120:121], v[8:11]
    v_mfma_f32_16x16x16_bf16 v[12:15], v[54:55], v[122:123], v[12:15]
    v_and_b32_dpp v44, v37, v19 quad_perm:[2,2,2,2] row_mask:0xf bank_mask:0xf
    v_and_b32_dpp v45, v37, v20 quad_perm:[2,2,2,2] row_mask:0xf bank_mask:0xf
    v_and_b32_dpp v46, v37, v19 quad_perm:[3,3,3,3] row_mask:0xf bank_mask:0xf
    v_and_b32_dpp v47, v37, v20 quad_perm:[3,3,3,3] row_mask:0xf bank_mask:0xf
    v_add_u32 v22, 1024, v22
    s_waitcnt vmcnt(10)
    buffer_load_dwordx4 v[120:123], v1, s[4:7], s67 offen offset:2304 nt
    s_add_u32 s21, s21, 1
    s_ff1_i32_b32 m0, s21
    s_nop 0
    s_movrels_b32 s67, s72
    s_xor_b32 s20, s20, s67
    s_cmp_lg_u32 s21, s60
    s_cbranch_scc1 L_loop2_2
    s_branch L_ctl2
L_loop2_4:
    v_mfma_f32_16x16x16_bf16 v[8:11], v[40:41], v[60:61], v[8:11]
    v_mfma_f32_16x16x16_bf16 v[12:15], v[40:41], v[62:63], v[12:15]
    v_add_f32 v18, v18, v36
    s_waitcnt lgkmcnt(1)
    v_sub_f32 v36, v39, v16
    v_mul_f32 v36, s22, v36
    v_exp_f32 v36, v36
    ds_read_b32 v39, v22 offset:768
    s_waitcnt vmcnt(12)
    buffer_load_dwordx4 v[60:63], v1, s[4:7], s20 offen offset:0 nt
    v_mfma_f32_16x16x16_bf16 v[8:11], v[42:43], v[64:65], v[8:11]
    v_mfma_f32_16x16x16_bf16 v[12:15], v[42:43], v[66:67], v[12:15]
    v_cvt_pk_bf16_f32 v37, v36, v36
    s_waitcnt vmcnt(12)
    buffer_load_dwordx4 v[64:67], v1, s[4:7], s20 offen offset:2048 nt
    v_mfma_f32_16x16x16_bf16 v[8:11], v[44:45], v[68:69], v[8:11]
    v_mfma_f32_16x16x16_bf16 v[12:15], v[44:45], v[70:71], v[12:15]
    v_and_b32_dpp v48, v37, v19 quad_perm:[0,0,0,0] row_mask:0xf bank_mask:0xf
    v_and_b32_dpp v49, v37, v20 quad_perm:[0,0,0,0] row_mask:0xf bank_mask:0xf
    v_and_b32_dpp v50, v37, v19 quad_perm:[1,1,1,1] row_mask:0xf bank_mask:0xf
    v_and_b32_dpp v51, v37, v20 quad_perm:[1,1,1,1] row_mask:0xf bank_mask:0xf
    s_waitcnt vmcnt(12)
    buffer_load_dwordx4 v[68:71], v1, s[4:7], s20 offen offset:256 nt
    v_mfma_f32_16x16x16_bf16 v[8:11], v[46:47], v[72:73], v[8:11]
    v_mfma_f32_16x16x16_bf16 v[12:15], v[46:47], v[74:75], v[12:15]
    v_and_b32_dpp v52, v37, v19 quad_perm:[2,2,2,2] row_mask:0xf bank_mask:0xf
    v_and_b32_dpp v53, v37, v20 quad_perm:[2,2,2,2] row_mask:0xf bank_mask:0xf
    v_and_b32_dpp v54, v37, v19 quad_perm:[3,3,3,3] row_mask:0xf bank_mask:0xf
    v_and_b32_dpp v55, v37, v20 quad_perm:[3,3,3,3] row_mask:0xf bank_mask:0xf
    s_waitcnt vmcnt(12)
    buffer_load_dwordx4 v[72:75], v1, s[4:7], s20 offen offset:2304 nt
    v_mfma_f32_16x16x16_bf16 v[8:11], v[48:49], v[76:77], v[8:11]
    v_mfma_f32_16x16x16_bf16 v[12:15], v[48:49], v[78:79], v[12:15]
    v_add_f32 v18, v18, v36
    s_waitcnt lgkmcnt(1)
    v_sub_f32 v36, v23, v16
    v_mul_f32 v36, s22, v36
    v_exp_f32 v36, v36
    ds_read_b32 v23, v22 offset:1024
    s_xor_b32 s67, s20, 0x4000
    s_waitcnt vmcnt(12)
    buffer_load_dwordx4 v[76:79], v1, s[4:7], s67 offen offset:0 nt
    v_mfma_f32_16x16x16_bf16 v[8:11], v[50:51], v[80:81], v[8:11]
    v_mfma_f32_16x16x16_bf16 v[12:15], v[50:51], v[82:83], v[12:15]
    v_cvt_pk_bf16_f32 v37, v36, v36
    s_waitcnt vmcnt(12)
    buffer_load_dwordx4 v[80:83], v1, s[4:7], s67 offen offset:2048 nt
    v_mfma_f32_16x16x16_bf16 v[8:11], v[52:53], v[84:85], v[8:11]
    v_mfma_f32_16x16x16_bf16 v[12:15], v[52:53], v[86:87], v[12:15]
    v_and_b32_dpp v40, v37, v19 quad_perm:[0,0,0,0] row_mask:0xf bank_mask:0xf
    v_and_b32_dpp v41, v37, v20 quad_perm:[0,0,0,0] row_mask:0xf bank_mask:0xf
    v_and_b32_dpp v42, v37, v19 quad_perm:[1,1,1,1] row_mask:0xf bank_mask:0xf
    v_and_b32_dpp v43, v37, v20 quad_perm:[1,1,1,1] row_mask:0xf bank_mask:0xf
    s_waitcnt vmcnt(12)
    buffer_load_dwordx4 v[84:87], v1, s[4:7], s67 offen offset:256 nt
    v_mfma_f32_16x16x16_bf16 v[8:11], v[54:55], v[88:89], v[8:11]
    v_mfma_f32_16x16x16_bf16 v[12:15], v[54:55], v[90:91], v[12:15]
    v_and_b32_dpp v44, v37, v19 quad_perm:[2,2,2,2] row_mask:0xf bank_mask:0xf
    v_and_b32_dpp v45, v37, v20 quad_perm:[2,2,2,2] row_mask:0xf bank_mask:0xf
    v_and_b32_dpp v46, v37, v19 quad_perm:[3,3,3,3] row_mask:0xf bank_mask:0xf
    v_and_b32_dpp v47, v37, v20 quad_perm:[3,3,3,3] row_mask:0xf bank_mask:0xf
    s_waitcnt vmcnt(12)
    buffer_load_dwordx4 v[88:91], v1, s[4:7], s67 offen offset:2304 nt
    v_mfma_f32_16x16x16_bf16 v[8:11], v[40:41], v[92:93], v[8:11]
    v_mfma_f32_16x16x16_bf16 v[12:15], v[40:41], v[94:95], v[12:15]
    v_add_f32 v18, v18, v36
    s_waitcnt lgkmcnt(1)
    v_sub_f32 v36, v39, v16
    v_mul_f32 v36, s22, v36
    v_exp_f32 v36, v36
    ds_read_b32 v39, v22 offset:1280
    s_xor_b32 s67, s20, 0x2000
    s_waitcnt vmcnt(12)
    buffer_load_dwordx4 v[92:95], v1, s[4:7], s67 offen offset:0 nt
    v_mfma_f32_16x16x16_bf16 v[8:11], v[42:43], v[96:97], v[8:11]
    v_mfma_f32_16x16x16_bf16 v[12:15], v[42:43], v[98:99], v[12:15]
    v_cvt_pk_bf16_f32 v37, v36, v36
    s_waitcnt vmcnt(12)
    buffer_load_dwordx4 v[96:99], v1, s[4:7], s67 offen offset:2048 nt
    v_mfma_f32_16x16x16_bf16 v[8:11], v[44:45], v[100:101], v[8:11]
    v_mfma_f32_16x16x16_bf16 v[12:15], v[44:45], v[102:103], v[12:15]
    v_and_b32_dpp v48, v37, v19 quad_perm:[0,0,0,0] row_mask:0xf bank_mask:0xf
    v_and_b32_dpp v49, v37, v20 quad_perm:[0,0,0,0] row_mask:0xf bank_mask:0xf
    v_and_b32_dpp v50, v37, v19 quad_perm:[1,1,1,1] row_mask:0xf bank_mask:0xf
    v_and_b32_dpp v51, v37, v20 quad_perm:[1,1,1,1] row_mask:0xf bank_mask:0xf
    s_waitcnt vmcnt(12)
    buffer_load_dwordx4 v[100:103], v1, s[4:7], s67 offen offset:256 nt
    v_mfma_f32_16x16x16_bf16 v[8:11], v[46:47], v[104:105], v[8:11]
    v_mfma_f32_16x16x16_bf16 v[12:15], v[46:47], v[106:107], v[12:15]
    v_and_b32_dpp v52, v37, v19 quad_perm:[2,2,2,2] row_mask:0xf bank_mask:0xf
    v_and_b32_dpp v53, v37, v20 quad_perm:[2,2,2,2] row_mask:0xf bank_mask:0xf
    v_and_b32_dpp v54, v37, v19 quad_perm:[3,3,3,3] row_mask:0xf bank_mask:0xf
    v_and_b32_dpp v55, v37, v20 quad_perm:[3,3,3,3] row_mask:0xf bank_mask:0xf
    s_waitcnt vmcnt(12)
    buffer_load_dwordx4 v[104:107], v1, s[4:7], s67 offen offset:2304 nt
    v_mfma_f32_16x16x16_bf16 v[8:11], v[48:49], v[108:109], v[8:11]
    v_mfma_f32_16x16x16_bf16 v[12:15], v[48:49], v[110:111], v[12:15]
    v_add_f32 v18, v18, v36
    s_waitcnt lgkmcnt(1)
    v_sub_f32 v36, v23, v16
    v_mul_f32 v36, s22, v36
    v_exp_f32 v36, v36
    ds_read_b32 v23, v22 offset:1536
    s_xor_b32 s67, s20, 0x6000
    s_waitcnt vmcnt(12)
    buffer_load_dwordx4 v[108:111], v1, s[4:7], s67 offen offset:0 nt
    v_mfma_f32_16x16x16_bf16 v[8:11], v[50:51], v[112:113], v[8:11]
    v_mfma_f32_16x16x16_bf16 v[12:15], v[50:51], v[114:115], v[12:15]
    v_cvt_pk_bf16_f32 v37, v36, v36
    s_waitcnt vmcnt(12)
    buffer_load_dwordx4 v[112:115], v1, s[4:7], s67 offen offset:2048 nt
    v_mfma_f32_16x16x16_bf16 v[8:11], v[52:53], v[116:117], v[8:11]
    v_mfma_f32_16x16x16_bf16 v[12:15], v[52:53], v[118:119], v[12:15]
    v_and_b32_dpp v40, v37, v19 quad_perm:[0,0,0,0] row_mask:0xf bank_mask:0xf
    v_and_b32_dpp v41, v37, v20 quad_perm:[0,0,0,0] row_mask:0xf bank_mask:0xf
    v_and_b32_dpp v42, v37, v19 quad_perm:[1,1,1,1] row_mask:0xf bank_mask:0xf
    v_and_b32_dpp v43, v37, v20 quad_perm:[1,1,1,1] row_mask:0xf bank_mask:0xf
    s_waitcnt vmcnt(12)
    buffer_load_dwordx4 v[116:119], v1, s[4:7], s67 offen offset:256 nt
    v_mfma_f32_16x16x16_bf16 v[8:11], v[54:55], v[120:121], v[8:11]
    v_mfma_f32_16x16x16_bf16 v[12:15], v[54:55], v[122:123], v[12:15]
    v_and_b32_dpp v44, v37, v19 quad_perm:[2,2,2,2] row_mask:0xf bank_mask:0xf
    v_and_b32_dpp v45, v37, v20 quad_perm:[2,2,2,2] row_mask:0xf bank_mask:0xf
    v_and_b32_dpp v46, v37, v19 quad_perm:[3,3,3,3] row_mask:0xf bank_mask:0xf
    v_and_b32_dpp v47, v37, v20 quad_perm:[3,3,3,3] row_mask:0xf bank_mask:0xf
    v_add_u32 v22, 1024, v22
    s_waitcnt vmcnt(12)
    buffer_load_dwordx4 v[120:123], v1, s[4:7], s67 offen offset:2304 nt
    s_add_u32 s21, s21, 1
    s_ff1_i32_b32 m0, s21
    s_nop 0
    s_movrels_b32 s67, s72
    s_xor_b32 s20, s20, s67
    s_cmp_lg_u32 s21, s60
    s_cbranch_scc1 L_loop2_4
    s_branch L_ctl2
L_loop2_5:
    v_mfma_f32_16x16x16_bf16 v[8:11], v[40:41], v[60:61], v[8:11]
    v_mfma_f32_16x16x16_bf16 v[12:15], v[40:41], v[62:63], v[12:15]
    v_add_f32 v18, v18, v36
    s_waitcnt lgkmcnt(1)
    v_sub_f32 v36, v39, v16
    v_mul_f32 v36, s22, v36
    v_exp_f32 v36, v36
    ds_read_b32 v39, v22 offset:768
    s_waitcnt vmcnt(13)
    buffer_load_dwordx4 v[60:63], v1, s[4:7], s20 offen offset:0 nt
    v_mfma_f32_16x16x16_bf16 v[8:11], v[42:43], v[64:65], v[8:11]
    v_mfma_f32_16x16x16_bf16 v[12:15], v[42:43], v[66:67], v[12:15]
    v_cvt_pk_bf16_f32 v37, v36, v36
    s_waitcnt vmcnt(13)
    buffer_load_dwordx4 v[64:67], v1, s[4:7], s20 offen offset:2048 nt
    v_mfma_f32_16x16x16_bf16 v[8:11], v[44:45], v[68:69], v[8:11]
    v_mfma_f32_16x16x16_bf16 v[12:15], v[44:45], v[70:71], v[12:15]
    v_and_b32_dpp v48, v37, v19 quad_perm:[0,0,0,0] row_mask:0xf bank_mask:0xf
    v_and_b32_dpp v49, v37, v20 quad_perm:[0,0,0,0] row_mask:0xf bank_mask:0xf
    v_and_b32_dpp v50, v37, v19 quad_perm:[1,1,1,1] row_mask:0xf bank_mask:0xf
    v_and_b32_dpp v51, v37, v20 quad_perm:[1,1,1,1] row_mask:0xf bank_mask:0xf
    s_waitcnt vmcnt(13)
    buffer_load_dwordx4 v[68:71], v1, s[4:7], s20 offen offset:256 nt
    v_mfma_f32_16x16x16_bf16 v[8:11], v[46:47], v[72:73], v[8:11]
    v_mfma_f32_16x16x16_bf16 v[12:15], v[46:47], v[74:75], v[12:15]
    v_and_b32_dpp v52, v37, v19 quad_perm:[2,2,2,2] row_mask:0xf bank_mask:0xf
    v_and_b32_dpp v53, v37, v20 quad_perm:[2,2,2,2] row_mask:0xf bank_mask:0xf
    v_and_b32_dpp v54, v37, v19 quad_perm:[3,3,3,3] row_mask:0xf bank_mask:0xf
    v_and_b32_dpp v55, v37, v20 quad_perm:[3,3,3,3] row_mask:0xf bank_mask:0xf
    s_waitcnt vmcnt(13)
    buffer_load_dwordx4 v[72:75], v1, s[4:7], s20 offen offset:2304 nt
    v_mfma_f32_16x16x16_bf16 v[8:11], v[48:49], v[76:77], v[8:11]
    v_mfma_f32_16x16x16_bf16 v[12:15], v[48:49], v[78:79], v[12:15]
    v_add_f32 v18, v18, v36
    s_waitcnt lgkmcnt(1)
    v_sub_f32 v36, v23, v16
    v_mul_f32 v36, s22, v36
    v_exp_f32 v36, v36
    ds_read_b32 v23, v22 offset:1024
    s_xor_b32 s67, s20, 0x4000
    s_waitcnt vmcnt(13)
    buffer_load_dwordx4 v[76:79], v1, s[4:7], s67 offen offset:0 nt
    v_mfma_f32_16x16x16_bf16 v[8:11], v[50:51], v[80:81], v[8:11]
    v_mfma_f32_16x16x16_bf16 v[12:15], v[50:51], v[82:83], v[12:15]
    v_cvt_pk_bf16_f32 v37, v36, v36
    s_waitcnt vmcnt(13)
    buffer_load_dwordx4 v[80:83], v1, s[4:7], s67 offen offset:2048 nt
    v_mfma_f32_16x16x16_bf16 v[8:11], v[52:53], v[84:85], v[8:11]
    v_mfma_f32_16x16x16_bf16 v[12:15], v[52:53], v[86:87], v[12:15]
    v_and_b32_dpp v40, v37, v19 quad_perm:[0,0,0,0] row_mask:0xf bank_mask:0xf
    v_and_b32_dpp v41, v37, v20 quad_perm:[0,0,0,0] row_mask:0xf bank_mask:0xf
    v_and_b32_dpp v42, v37, v19 quad_perm:[1,1,1,1] row_mask:0xf bank_mask:0xf
    v_and_b32_dpp v43, v37, v20 quad_perm:[1,1,1,1] row_mask:0xf bank_mask:0xf
    s_waitcnt vmcnt(13)
    buffer_load_dwordx4 v[84:87], v1, s[4:7], s67 offen offset:256 nt
    v_mfma_f32_16x16x16_bf16 v[8:11], v[54:55], v[88:89], v[8:11]
    v_mfma_f32_16x16x16_bf16 v[12:15], v[54:55], v[90:91], v[12:15]
    v_and_b32_dpp v44, v37, v19 quad_perm:[2,2,2,2] row_mask:0xf bank_mask:0xf
    v_and_b32_dpp v45, v37, v20 quad_perm:[2,2,2,2] row_mask:0xf bank_mask:0xf
    v_and_b32_dpp v46, v37, v19 quad_perm:[3,3,3,3] row_mask:0xf bank_mask:0xf
    v_and_b32_dpp v47, v37, v20 quad_perm:[3,3,3,3] row_mask:0xf bank_mask:0xf
    s_waitcnt vmcnt(13)
    buffer_load_dwordx4 v[88:91], v1, s[4:7], s67 offen offset:2304 nt
    v_mfma_f32_16x16x16_bf16 v[8:11], v[40:41], v[92:93], v[8:11]
    v_mfma_f32_16x16x16_bf16 v[12:15], v[40:41], v[94:95], v[12:15]
    v_add_f32 v18, v18, v36
    s_waitcnt lgkmcnt(1)
    v_sub_f32 v36, v39, v16
    v_mul_f32 v36, s22, v36
    v_exp_f32 v36, v36
    ds_read_b32 v39, v22 offset:1280
    s_xor_b32 s67, s20, 0x2000
    s_waitcnt vmcnt(13)
    buffer_load_dwordx4 v[92:95], v1, s[4:7], s67 offen offset:0 nt
    v_mfma_f32_16x16x16_bf16 v[8:11], v[42:43], v[96:97], v[8:11]
    v_mfma_f32_16x16x16_bf16 v[12:15], v[42:43], v[98:99], v[12:15]
    v_cvt_pk_bf16_f32 v37, v36, v36
    s_waitcnt vmcnt(13)
    buffer_load_dwordx4 v[96:99], v1, s[4:7], s67 offen offset:2048 nt
    v_mfma_f32_16x16x16_bf16 v[8:11], v[44:45], v[100:101], v[8:11]
    v_mfma_f32_16x16x16_bf16 v[12:15], v[44:45], v[102:103], v[12:15]
    v_and_b32_dpp v48, v37, v19 quad_perm:[0,0,0,0] row_mask:0xf bank_mask:0xf
    v_and_b32_dpp v49, v37, v20 quad_perm:[0,0,0,0] row_mask:0xf bank_mask:0xf
    v_and_b32_dpp v50, v37, v19 quad_perm:[1,1,1,1] row_mask:0xf bank_mask:0xf
    v_and_b32_dpp v51, v37, v20 quad_perm:[1,1,1,1] row_mask:0xf bank_mask:0xf
    s_waitcnt vmcnt(13)
    buffer_load_dwordx4 v[100:103], v1, s[4:7], s67 offen offset:256 nt
    v_mfma_f32_16x16x16_bf16 v[8:11], v[46:47], v[104:105], v[8:11]
    v_mfma_f32_16x16x16_bf16 v[12:15], v[46:47], v[106:107], v[12:15]
    v_and_b32_dpp v52, v37, v19 quad_perm:[2,2,2,2] row_mask:0xf bank_mask:0xf
    v_and_b32_dpp v53, v37, v20 quad_perm:[2,2,2,2] row_mask:0xf bank_mask:0xf
    v_and_b32_dpp v54, v37, v19 quad_perm:[3,3,3,3] row_mask:0xf bank_mask:0xf
    v_and_b32_dpp v55, v37, v20 quad_perm:[3,3,3,3] row_mask:0xf bank_mask:0xf
    s_waitcnt vmcnt(13)
    buffer_load_dwordx4 v[104:107], v1, s[4:7], s67 offen offset:2304 nt
    v_mfma_f32_16x16x16_bf16 v[8:11], v[48:49], v[108:109], v[8:11]
    v_mfma_f32_16x16x16_bf16 v[12:15], v[48:49], v[110:111], v[12:15]
    v_add_f32 v18, v18, v36
    s_waitcnt lgkmcnt(1)
    v_sub_f32 v36, v23, v16
    v_mul_f32 v36, s22, v36
    v_exp_f32 v36, v36
    ds_read_b32 v23, v22 offset:1536
    s_xor_b32 s67, s20, 0x6000
    s_waitcnt vmcnt(13)
    buffer_load_dwordx4 v[108:111], v1, s[4:7], s67 offen offset:0 nt
    v_mfma_f32_16x16x16_bf16 v[8:11], v[50:51], v[112:113], v[8:11]
    v_mfma_f32_16x16x16_bf16 v[12:15], v[50:51], v[114:115], v[12:15]
    v_cvt_pk_bf16_f32 v37, v36, v36
    s_waitcnt vmcnt(13)
    buffer_load_dwordx4 v[112:115], v1, s[4:7], s67 offen offset:2048 nt
    v_mfma_f32_16x16x16_bf16 v[8:11], v[52:53], v[116:117], v[8:11]
    v_mfma_f32_16x16x16_bf16 v[12:15], v[52:53], v[118:119], v[12:15]
    v_and_b32_dpp v40, v37, v19 quad_perm:[0,0,0,0] row_mask:0xf bank_mask:0xf
    v_and_b32_dpp v41, v37, v20 quad_perm:[0,0,0,0] row_mask:0xf bank_mask:0xf
    v_and_b32_dpp v42, v37, v19 quad_perm:[1,1,1,1] row_mask:0xf bank_mask:0xf
    v_and_b32_dpp v43, v37, v20 quad_perm:[1,1,1,1] row_mask:0xf bank_mask:0xf
    s_waitcnt vmcnt(13)
    buffer_load_dwordx4 v[116:119], v1, s[4:7], s67 offen offset:256 nt
    v_mfma_f32_16x16x16_bf16 v[8:11], v[54:55], v[120:121], v[8:11]
    v_mfma_f32_16x16x16_bf16 v[12:15], v[54:55], v[122:123], v[12:15]
    v_and_b32_dpp v44, v37, v19 quad_perm:[2,2,2,2] row_mask:0xf bank_mask:0xf
    v_and_b32_dpp v45, v37, v20 quad_perm:[2,2,2,2] row_mask:0xf bank_mask:0xf
    v_and_b32_dpp v46, v37, v19 quad_perm:[3,3,3,3] row_mask:0xf bank_mask:0xf
    v_and_b32_dpp v47, v37, v20 quad_perm:[3,3,3,3] row_mask:0xf bank_mask:0xf
    v_add_u32 v22, 1024, v22
    s_waitcnt vmcnt(13)
    buffer_load_dwordx4 v[120:123], v1, s[4:7], s67 offen offset:2304 nt
    s_add_u32 s21, s21, 1
    s_ff1_i32_b32 m0, s21
    s_nop 0
    s_movrels_b32 s67, s72
    s_xor_b32 s20, s20, s67
    s_cmp_lg_u32 s21, s60
    s_cbranch_scc1 L_loop2_5
    s_branch L_ctl2
L_boost2:
    s_add_u32 s57, s61, s21
    s_min_u32 s60, s60, s57
    s_sub_u32 s61, s57, s60
    s_add_u32 s58, s58, s39
    s_branch L_pick2
L_other2:
    s_cmp_eq_u32 s58, 3
    s_cbranch_scc1 L_loop2_3
    s_cmp_eq_u32 s58, 0
    s_cbranch_scc1 L_loop2_0
    s_cmp_eq_u32 s58, 2
    s_cbranch_scc1 L_loop2_2
    s_cmp_eq_u32 s58, 4
    s_cbranch_scc1 L_loop2_4
    s_branch L_loop2_5
L_ctl2:
    s_cmp_eq_u32 s59, 0
    s_cbranch_scc1 L_nocons2
    s_mov_b32 s59, 0
    s_waitcnt lgkmcnt(0)
    s_min_u32 s57, s65, 31
    s_lshl_b32 s57, s57, 1
    s_sub_i32 s57, s57, 31
    s_mul_i32 s58, s57, s57
    s_mul_i32 s58, s58, 2253
    s_lshr_b32 s58, s58, 8
    s_add_u32 s58, s58, 6342
    s_mul_i32 s61, s58, s57
    s_add_i32 s61, s61, 0x8000
    s_ashr_i32 s61, s61, 16
    s_cmp_gt_i32 s61, 0
    s_cselect_b32 s39, 2, -1
    s_abs_i32 s61, s61
    s_add_u32 s33, s33, 1
    s_cmp_gt_i32 s57, 21
    s_cselect_b32 s33, s33, 0
    s_cmp_gt_u32 s33, 2
    s_addc_u32 s66, s66, 0
    s_cmp_lt_i32 s57, 0
    s_subb_u32 s66, s66, 0
    s_max_u32 s66, s66, 1
    s_min_u32 s66, s66, 5
L_nocons2:
    s_sub_u32 s57, s21, 66
    s_bitcmp1_b64 s[82:83], s57
    s_cbranch_scc0 L_norep2
    s_add_u32 s64, s64, s63
    s_and_b32 s57, s64, 15
    s_add_u32 s57, s57, s62
    s_lshl_b32 s57, s57, 8
    s_add_u32 s62, s62, 16
    s_mov_b32 s65, 1
    s_mov_b32 s59, 1
    s_atomic_add s65, s[68:69], s57 glc
L_norep2:
    s_cmp_lt_u32 s21, 128
    s_cbranch_scc1 L_plan2
L_exit2:
    s_waitcnt vmcnt(15)
    v_mfma_f32_16x16x16_bf16 v[8:11], v[40:41], v[60:61], v[8:11]
    v_mfma_f32_16x16x16_bf16 v[12:15], v[40:41], v[62:63], v[12:15]
    v_add_f32 v18, v18, v36
    s_waitcnt lgkmcnt(1)
    v_sub_f32 v36, v39, v16
    v_mul_f32 v36, s22, v36
    v_exp_f32 v36, v36
    ds_read_b32 v39, v22 offset:768
    s_waitcnt vmcnt(14)
    v_mfma_f32_16x16x16_bf16 v[8:11], v[42:43], v[64:65], v[8:11]
    v_mfma_f32_16x16x16_bf16 v[12:15], v[42:43], v[66:67], v[12:15]
    v_cvt_pk_bf16_f32 v37, v36, v36
    s_waitcnt vmcnt(13)
    v_mfma_f32_16x16x16_bf16 v[8:11], v[44:45], v[68:69], v[8:11]
    v_mfma_f32_16x16x16_bf16 v[12:15], v[44:45], v[70:71], v[12:15]
    v_and_b32_dpp v48, v37, v19 quad_perm:[0,0,0,0] row_mask:0xf bank_mask:0xf
    v_and_b32_dpp v49, v37, v20 quad_perm:[0,0,0,0] row_mask:0xf bank_mask:0xf
    v_and_b32_dpp v50, v37, v19 quad_perm:[1,1,1,1] row_mask:0xf bank_mask:0xf
    v_and_b32_dpp v51, v37, v20 quad_perm:[1,1,1,1] row_mask:0xf bank_mask:0xf
    s_waitcnt vmcnt(12)
    v_mfma_f32_16x16x16_bf16 v[8:11], v[46:47], v[72:73], v[8:11]
    v_mfma_f32_16x16x16_bf16 v[12:15], v[46:47], v[74:75], v[12:15]
    v_and_b32_dpp v52, v37, v19 quad_perm:[2,2,2,2] row_mask:0xf bank_mask:0xf
    v_and_b32_dpp v53, v37, v20 quad_perm:[2,2,2,2] row_mask:0xf bank_mask:0xf
    v_and_b32_dpp v54, v37, v19 quad_perm:[3,3,3,3] row_mask:0xf bank_mask:0xf
    v_and_b32_dpp v55, v37, v20 quad_perm:[3,3,3,3] row_mask:0xf bank_mask:0xf
    s_waitcnt vmcnt(11)
    v_mfma_f32_16x16x16_bf16 v[8:11], v[48:49], v[76:77], v[8:11]
    v_mfma_f32_16x16x16_bf16 v[12:15], v[48:49], v[78:79], v[12:15]
    v_add_f32 v18, v18, v36
    s_waitcnt lgkmcnt(1)
    v_sub_f32 v36, v23, v16
    v_mul_f32 v36, s22, v36
    v_exp_f32 v36, v36
    ds_read_b32 v23, v22 offset:1024
    s_waitcnt vmcnt(10)
    v_mfma_f32_16x16x16_bf16 v[8:11], v[50:51], v[80:81], v[8:11]
    v_mfma_f32_16x16x16_bf16 v[12:15], v[50:51], v[82:83], v[12:15]
    v_cvt_pk_bf16_f32 v37, v36, v36
    s_waitcnt vmcnt(9)
    v_mfma_f32_16x16x16_bf16 v[8:11], v[52:53], v[84:85], v[8:11]
    v_mfma_f32_16x16x16_bf16 v[12:15], v[52:53], v[86:87], v[12:15]
    v_and_b32_dpp v40, v37, v19 quad_perm:[0,0,0,0] row_mask:0xf bank_mask:0xf
    v_and_b32_dpp v41, v37, v20 quad_perm:[0,0,0,0] row_mask:0xf bank_mask:0xf
    v_and_b32_dpp v42, v37, v19 quad_perm:[1,1,1,1] row_mask:0xf bank_mask:0xf
    v_and_b32_dpp v43, v37, v20 quad_perm:[1,1,1,1] row_mask:0xf bank_mask:0xf
    s_waitcnt vmcnt(8)
    v_mfma_f32_16x16x16_bf16 v[8:11], v[54:55], v[88:89], v[8:11]
    v_mfma_f32_16x16x16_bf16 v[12:15], v[54:55], v[90:91], v[12:15]
    v_and_b32_dpp v44, v37, v19 quad_perm:[2,2,2,2] row_mask:0xf bank_mask:0xf
    v_and_b32_dpp v45, v37, v20 quad_perm:[2,2,2,2] row_mask:0xf bank_mask:0xf
    v_and_b32_dpp v46, v37, v19 quad_perm:[3,3,3,3] row_mask:0xf bank_mask:0xf
    v_and_b32_dpp v47, v37, v20 quad_perm:[3,3,3,3] row_mask:0xf bank_mask:0xf
    s_waitcnt vmcnt(7)
    v_mfma_f32_16x16x16_bf16 v[8:11], v[40:41], v[92:93], v[8:11]
    v_mfma_f32_16x16x16_bf16 v[12:15], v[40:41], v[94:95], v[12:15]
    v_add_f32 v18, v18, v36
    s_waitcnt lgkmcnt(1)
    v_sub_f32 v36, v39, v16
    v_mul_f32 v36, s22, v36
    v_exp_f32 v36, v36
    ds_read_b32 v39, v22 offset:1280
    s_waitcnt vmcnt(6)
    v_mfma_f32_16x16x16_bf16 v[8:11], v[42:43], v[96:97], v[8:11]
    v_mfma_f32_16x16x16_bf16 v[12:15], v[42:43], v[98:99], v[12:15]
    v_cvt_pk_bf16_f32 v37, v36, v36
    s_waitcnt vmcnt(5)
    v_mfma_f32_16x16x16_bf16 v[8:11], v[44:45], v[100:101], v[8:11]
    v_mfma_f32_16x16x16_bf16 v[12:15], v[44:45], v[102:103], v[12:15]
    v_and_b32_dpp v48, v37, v19 quad_perm:[0,0,0,0] row_mask:0xf bank_mask:0xf
    v_and_b32_dpp v49, v37, v20 quad_perm:[0,0,0,0] row_mask:0xf bank_mask:0xf
    v_and_b32_dpp v50, v37, v19 quad_perm:[1,1,1,1] row_mask:0xf bank_mask:0xf
    v_and_b32_dpp v51, v37, v20 quad_perm:[1,1,1,1] row_mask:0xf bank_mask:0xf
    s_waitcnt vmcnt(4)
    v_mfma_f32_16x16x16_bf16 v[8:11], v[46:47], v[104:105], v[8:11]
    v_mfma_f32_16x16x16_bf16 v[12:15], v[46:47], v[106:107], v[12:15]
    v_and_b32_dpp v52, v37, v19 quad_perm:[2,2,2,2] row_mask:0xf bank_mask:0xf
    v_and_b32_dpp v53, v37, v20 quad_perm:[2,2,2,2] row_mask:0xf bank_mask:0xf
    v_and_b32_dpp v54, v37, v19 quad_perm:[3,3,3,3] row_mask:0xf bank_mask:0xf
    v_and_b32_dpp v55, v37, v20 quad_perm:[3,3,3,3] row_mask:0xf bank_mask:0xf
    v_add_f32 v18, v18, v36
    s_nop 1
    v_add_f32_dpp v18, v18, v18 quad_perm:[1,0,3,2] row_mask:0xf bank_mask:0xf
    s_nop 1
    v_add_f32_dpp v18, v18, v18 quad_perm:[2,3,0,1] row_mask:0xf bank_mask:0xf
    v_mov_b32 v21, v18
    s_nop 1
    v_permlane16_swap_b32 v18, v21
    s_nop 1
    v_add_f32 v18, v18, v21
    v_mov_b32 v21, v18
    s_nop 1
    v_permlane32_swap_b32 v18, v21
    s_nop 1
    v_add_f32 v18, v18, v21
    v_rcp_f32 v18, v18
    s_nop 1
    v_mov_b32_dpp v32, v18 row_newbcast:0 row_mask:0x1 bank_mask:0xf
    v_mov_b32_dpp v32, v18 row_newbcast:4 row_mask:0x2 bank_mask:0xf
    v_mov_b32_dpp v32, v18 row_newbcast:8 row_mask:0x4 bank_mask:0xf
    v_mov_b32_dpp v32, v18 row_newbcast:12 row_mask:0x8 bank_mask:0xf
    s_waitcnt vmcnt(3)
    v_mfma_f32_16x16x16_bf16 v[8:11], v[48:49], v[108:109], v[8:11]
    v_mfma_f32_16x16x16_bf16 v[12:15], v[48:49], v[110:111], v[12:15]
    s_waitcnt vmcnt(2)
    v_mfma_f32_16x16x16_bf16 v[8:11], v[50:51], v[112:113], v[8:11]
    v_mfma_f32_16x16x16_bf16 v[12:15], v[50:51], v[114:115], v[12:15]
    s_waitcnt vmcnt(1)
    v_mfma_f32_16x16x16_bf16 v[8:11], v[52:53], v[116:117], v[8:11]
    v_mfma_f32_16x16x16_bf16 v[12:15], v[52:53], v[118:119], v[12:15]
    s_waitcnt vmcnt(0)
    v_mfma_f32_16x16x16_bf16 v[8:11], v[54:55], v[120:121], v[8:11]
    v_mfma_f32_16x16x16_bf16 v[12:15], v[54:55], v[122:123], v[12:15]
    s_nop 7
    v_mul_f32 v8, v8, v32
    v_mul_f32 v9, v9, v32
    v_mul_f32 v10, v10, v32
    v_mul_f32 v11, v11, v32
    v_mul_f32 v12, v12, v32
    v_mul_f32 v13, v13, v32
    v_mul_f32 v14, v14, v32
    v_mul_f32 v15, v15, v32
    v_cvt_pk_bf16_f32 v4, v8, v9
    v_cvt_pk_bf16_f32 v5, v10, v11
    v_cvt_pk_bf16_f32 v6, v12, v13
    v_cvt_pk_bf16_f32 v7, v14, v15
    buffer_store_dwordx4 v[4:7], v56, s[16:19], 0 offen
L_end:
    s_endpgm
.section .rodata,"a"
.p2align 6
.amdhsa_kernel standalone__softmax_full_bidir__sampling_kernel
  .amdhsa_next_free_vgpr 124
  .amdhsa_next_free_sgpr 84
  .amdhsa_accum_offset 124
  .amdhsa_group_segment_fixed_size 0
  .amdhsa_kernarg_size 48
  .amdhsa_user_sgpr_count 2
  .amdhsa_user_sgpr_kernarg_segment_ptr 1
  .amdhsa_system_sgpr_workgroup_id_x 1
.end_amdhsa_kernel
```
